```python
import torch

def _softmax(x, axis=-1):
    return torch.softmax(x, dim=axis)
def _gelu(x):
    return torch.nn.functional.gelu(x, approximate="tanh")
def _silu(x):
    return torch.nn.functional.silu(x)
def _sigmoid(x):
    return torch.sigmoid(x)
def _layernorm(x, axis=-1, eps=1e-5):
    m = x.mean(dim=axis, keepdim=True)
    v = x.var(dim=axis, keepdim=True, unbiased=False)
    return (x - m) / torch.sqrt(v + eps)
def _scatter_add(tgt, idx, src, axis=0):
    return tgt.clone().index_add_(axis, idx, src)
def _segment_sum(src, seg, n):
    out = torch.zeros((n,) + src.shape[1:], dtype=src.dtype)
    return out.index_add_(0, seg, src)
def _pad(x, pw):
    flat = tuple(v for pair in reversed(pw) for v in pair)
    return torch.nn.functional.pad(x, flat)

kernel_name = 'concat_heads__gqa_block_cached__gqa_block_cached__near_ridge'

def setup_inputs():

    _w = (lambda a: (lambda t: t.to(torch.bfloat16) if t.is_floating_point() else t)(torch.as_tensor(a)))
    def _A_setup():
        B, Sq, D = 32, 64, 576
        Hq, Hkv, Sk, Dh = 32, 16, 512, 128
        assert Hq % Hkv == 0, (Hq, Hkv)
        return {
            "x": _w((lambda *s: torch.randn(*s, dtype=torch.bfloat16) * 0.8)(B, Sq, D)),
            "k_cache": _w((lambda *s: torch.randn(*s, dtype=torch.bfloat16) * 0.8)(B, Hkv, Sk, Dh)),
            "v_cache": _w((lambda *s: torch.randn(*s, dtype=torch.bfloat16) * 0.05)(B, Hkv, Sk, Dh)),
            "wq": _w((lambda *s: torch.randn(*s, dtype=torch.bfloat16) * 0.8)(D, Hq * Dh) * (D ** -0.5)),
            "wo": _w((lambda *s: torch.randn(*s, dtype=torch.bfloat16) * 0.05)(Hq * Dh, D) * ((Hq * Dh) ** -0.5)),
        }
    _A_in = _A_setup()

    def _B_setup():
        B, Sq, D = 32, 64, 576
        Hq, Hkv, Sk, Dh = 32, 16, 512, 128
        assert Hq % Hkv == 0, (Hq, Hkv)
        return {
            "x": _w((lambda *s: torch.randn(*s, dtype=torch.bfloat16) * 0.8)(B, Sq, D)),
            "k_cache": _w((lambda *s: torch.randn(*s, dtype=torch.bfloat16) * 0.8)(B, Hkv, Sk, Dh)),
            "v_cache": _w((lambda *s: torch.randn(*s, dtype=torch.bfloat16) * 0.05)(B, Hkv, Sk, Dh)),
            "wq": _w((lambda *s: torch.randn(*s, dtype=torch.bfloat16) * 0.8)(D, Hq * Dh) * (D ** -0.5)),
            "wo": _w((lambda *s: torch.randn(*s, dtype=torch.bfloat16) * 0.05)(Hq * Dh, D) * ((Hq * Dh) ** -0.5)),
        }
    _B_in = _B_setup()

    return {
        "A_x": _A_in["x"],
        "A_k_cache": _A_in["k_cache"],
        "A_v_cache": _A_in["v_cache"],
        "A_wq": _A_in["wq"],
        "A_wo": _A_in["wo"],
        "B_x": _B_in["x"],
        "B_k_cache": _B_in["k_cache"],
        "B_v_cache": _B_in["v_cache"],
        "B_wq": _B_in["wq"],
        "B_wo": _B_in["wo"],
    }

def reference(A_x, A_k_cache, A_v_cache, A_wq, A_wo, B_x, B_k_cache, B_v_cache, B_wq, B_wo):
    def _A_ref(x, k_cache, v_cache, wq, wo):
        B, Sq, D = x.shape
        Hq, Dh = 32, 128
        Hkv = k_cache.shape[1]
        rep = Hq // Hkv
        q = (lambda x, *d: x.permute(*d))((x @ wq).reshape(B, Sq, Hq, Dh), 0, 2, 1, 3)
        k = (lambda x, n, axis: torch.repeat_interleave(x, n, dim=axis))(k_cache, rep, axis=1)
        v = (lambda x, n, axis: torch.repeat_interleave(x, n, dim=axis))(v_cache, rep, axis=1)
        scores = torch.einsum("bhqd,bhkd->bhqk", q, k) * (Dh ** -0.5)
        p = _softmax(scores, axis=-1)
        o = torch.einsum("bhqk,bhkd->bhqd", p, v)
        return (lambda x, *d: x.permute(*d))(o, 0, 2, 1, 3).reshape(B, Sq, Hq * Dh) @ wo

    def _B_ref(x, k_cache, v_cache, wq, wo):
        B, Sq, D = x.shape
        Hq, Dh = 32, 128
        Hkv = k_cache.shape[1]
        rep = Hq // Hkv
        q = (lambda x, *d: x.permute(*d))((x @ wq).reshape(B, Sq, Hq, Dh), 0, 2, 1, 3)
        k = (lambda x, n, axis: torch.repeat_interleave(x, n, dim=axis))(k_cache, rep, axis=1)
        v = (lambda x, n, axis: torch.repeat_interleave(x, n, dim=axis))(v_cache, rep, axis=1)
        scores = torch.einsum("bhqd,bhkd->bhqk", q, k) * (Dh ** -0.5)
        p = _softmax(scores, axis=-1)
        o = torch.einsum("bhqk,bhkd->bhqd", p, v)
        return (lambda x, *d: x.permute(*d))(o, 0, 2, 1, 3).reshape(B, Sq, Hq * Dh) @ wo

    a = _A_ref(A_x, A_k_cache, A_v_cache, A_wq, A_wo)
    b = _B_ref(B_x, B_k_cache, B_v_cache, B_wq, B_wo)
    return torch.concatenate([a, b], axis=-1)
```

```asm
; @launch kernel=fused_kernel grid=(256,1,1) block=(512,1,1) lds=163840
; @launch kernel=reduce_kernel grid=(1152,1,1) block=(256,1,1) lds=0
.amdgcn_target "amdgcn-amd-amdhsa--gfx950"
.text
.globl fused_kernel
.p2align 8
.type fused_kernel,@function
fused_kernel:
    s_cmp_ge_u32 s2, 256
    s_cbranch_scc1 LF_done
    s_load_dwordx8 s[72:79], s[0:1], 0
    s_load_dwordx2 s[80:81], s[0:1], 32
    s_load_dwordx8 s[84:91], s[0:1], 40
    s_load_dwordx2 s[92:93], s[0:1], 72
    s_load_dwordx2 s[94:95], s[0:1], 96
    s_and_b32 s30, s2, 7
    s_lshr_b32 s49, s30, 2
    s_and_b32 s47, s30, 3
    s_lshr_b32 s48, s2, 3
    s_add_u32 s32, s48, s47
    s_and_b32 s32, s32, 1
    v_and_b32 v1, 63, v0
    v_lshrrev_b32 v2, 6, v0
    s_nop 0
    v_readfirstlane_b32 s28, v2
    s_lshr_b32 s29, s28, 2
    s_and_b32 s50, s28, 3
    s_mov_b32 s33, 0x3e0293ee
    s_mov_b32 s34, 0x427af233
    s_waitcnt lgkmcnt(0)
    s_cmp_eq_u32 s49, 0
    s_cselect_b64 s[72:73], s[72:73], s[84:85]
    s_cselect_b64 s[74:75], s[74:75], s[86:87]
    s_cselect_b64 s[76:77], s[76:77], s[88:89]
    s_cselect_b64 s[78:79], s[78:79], s[90:91]
    s_cselect_b64 s[80:81], s[80:81], s[92:93]
    s_mov_b32 s4, s72
    s_and_b32 s5, s73, 0xffff
    s_mov_b32 s6, 0x240000
    s_mov_b32 s7, 0x00020000
    s_mov_b32 s8, s74
    s_and_b32 s9, s75, 0xffff
    s_mov_b32 s10, 0x4000000
    s_mov_b32 s11, 0x00020000
    s_mov_b32 s12, s76
    s_and_b32 s13, s77, 0xffff
    s_mov_b32 s14, 0x4000000
    s_mov_b32 s15, 0x00020000
    s_mov_b32 s16, s78
    s_and_b32 s17, s79, 0xffff
    s_mov_b32 s18, 0x480000
    s_mov_b32 s19, 0x00020000
    s_mov_b32 s20, s80
    s_and_b32 s21, s81, 0xffff
    s_mov_b32 s22, 0x480000
    s_mov_b32 s23, 0x00020000
    s_mov_b32 s24, s94
    s_and_b32 s25, s95, 0xffff
    s_mov_b32 s26, 0x2400000
    s_mov_b32 s27, 0x00020000
    s_lshl_b32 s39, s48, 4
    s_lshl_b32 s30, s47, 2
    s_add_u32 s39, s39, s30
    s_add_u32 s39, s39, s29
    s_lshl_b32 s39, s39, 17
    s_lshl_b32 s30, s50, 12
    s_add_u32 s39, s39, s30
    s_lshl_b32 s40, s29, 16
    s_add_u32 s40, s40, s30
    s_lshl_b32 s51, s28, 12
    s_lshl_b32 s52, s28, 10
    s_lshl_b32 s42, s48, 6
    s_lshl_b32 s30, s28, 3
    s_add_u32 s42, s42, s30
    s_mulk_i32 s42, 1152
    s_lshl_b32 s54, s49, 5
    s_add_u32 s54, s54, s48
    s_lshl_b32 s54, s54, 2
    s_add_u32 s54, s54, s47
    s_mul_i32 s54, s54, 147456
    v_lshrrev_b32 v4, 4, v1
    v_and_b32 v5, 15, v1
    v_add_u32 v6, 0, v4
    v_xor_b32 v6, v6, v5
    v_lshlrev_b32 v6, 4, v6
    v_lshl_add_u32 v27, v4, 8, v6
    v_add_u32 v6, 4, v4
    v_xor_b32 v6, v6, v5
    v_lshlrev_b32 v6, 4, v6
    v_lshl_add_u32 v28, v4, 8, v6
    v_add_u32 v6, 8, v4
    v_xor_b32 v6, v6, v5
    v_lshlrev_b32 v6, 4, v6
    v_lshl_add_u32 v29, v4, 8, v6
    v_add_u32 v6, 12, v4
    v_xor_b32 v6, v6, v5
    v_lshlrev_b32 v6, 4, v6
    v_lshl_add_u32 v30, v4, 8, v6
    v_lshlrev_b32 v6, 2, v4
    v_xor_b32 v6, v6, v5
    v_lshlrev_b32 v6, 4, v6
    v_lshl_add_u32 v31, v4, 8, v6
    s_mov_b32 s35, 1
    s_and_b32 s66, s48, 7
    s_lshl_b32 s38, s66, 14
    s_add_u32 s38, s38, s39
    s_mov_b32 s57, s38
    s_mov_b32 s37, 0
    s_mov_b32 s63, 0
    s_mov_b32 s64, 1
    s_mov_b32 s65, 1
    s_call_b64 s[58:59], LF_Q
    s_nop 7
    s_nop 7
    s_mov_b32 s35, 0
    s_call_b64 s[58:59], LF_S
    s_nop 7
    s_nop 7
    v_swap_b32 v32, v64
    v_swap_b32 v33, v65
    v_swap_b32 v34, v66
    v_swap_b32 v35, v67
    v_swap_b32 v36, v68
    v_swap_b32 v37, v69
    v_swap_b32 v38, v70
    v_swap_b32 v39, v71
    v_swap_b32 v40, v72
    v_swap_b32 v41, v73
    v_swap_b32 v42, v74
    v_swap_b32 v43, v75
    v_swap_b32 v44, v76
    v_swap_b32 v45, v77
    v_swap_b32 v46, v78
    v_swap_b32 v47, v79
    v_swap_b32 v48, v80
    v_swap_b32 v49, v81
    v_swap_b32 v50, v82
    v_swap_b32 v51, v83
    v_swap_b32 v52, v84
    v_swap_b32 v53, v85
    v_swap_b32 v54, v86
    v_swap_b32 v55, v87
    v_swap_b32 v56, v88
    v_swap_b32 v57, v89
    v_swap_b32 v58, v90
    v_swap_b32 v59, v91
    v_swap_b32 v60, v92
    v_swap_b32 v61, v93
    v_swap_b32 v62, v94
    v_swap_b32 v63, v95
    s_mov_b32 s35, 1
    s_mov_b32 s64, 3
    s_mov_b32 s65, 0
    s_call_b64 s[58:59], LF_S
    s_nop 7
    s_nop 7
    s_mov_b32 s35, 0
    s_call_b64 s[58:59], LF_O
    s_nop 7
    s_nop 7
LF_end:
LF_done:
    s_endpgm
LF_Q:
    v_xor_b32 v21, 0, v1
    v_lshlrev_b32 v21, 4, v21
    v_add_u32 v4, 0, v21
    v_xor_b32 v21, 4, v1
    v_lshlrev_b32 v21, 4, v21
    v_add_u32 v5, 7168, v21
    v_xor_b32 v21, 8, v1
    v_lshlrev_b32 v21, 4, v21
    v_add_u32 v6, 14336, v21
    v_xor_b32 v21, 12, v1
    v_lshlrev_b32 v21, 4, v21
    v_add_u32 v7, 21504, v21
    s_and_b32 s30, s28, 1
    s_lshl_b32 s30, s30, 2
    v_lshrrev_b32 v21, 4, v1
    v_add_u32 v21, s30, v21
    v_and_b32 v22, 7, v1
    v_xor_b32 v21, v21, v22
    v_lshlrev_b32 v21, 4, v21
    v_lshrrev_b32 v22, 3, v1
    v_mul_u32_u24 v22, 1152, v22
    v_add_u32 v12, v21, v22
    s_lshl_b32 s41, s47, 1
    s_add_u32 s41, s41, s35
    s_lshl_b32 s41, s41, 10
    s_lshl_b32 s30, s28, 15
    s_add_u32 s41, s41, s30
    s_mul_i32 s30, s48, 57
    s_lshr_b32 s30, s30, 9
    s_mul_i32 s30, s30, 9
    s_sub_u32 s46, s48, s30
    s_lshl_b32 s45, s46, 1
    s_mov_b32 s56, 0
    s_barrier
    s_lshl_b32 s44, s46, 7
    s_add_u32 s44, s44, s42
    s_add_u32 s46, s46, 1
    s_cmp_eq_u32 s46, 9
    s_cselect_b32 s46, 0, s46
    s_add_u32 m0, s52, 49152
    s_nop 0
    buffer_load_dwordx4 v12, s[4:7], s44 offen  lds
    s_lshl_b32 s43, s45, 18
    s_add_u32 s43, s43, s41
    s_add_u32 s45, s45, 1
    s_cmp_eq_u32 s45, 18
    s_cselect_b32 s45, 0, s45
    s_add_u32 s56, s56, 1
    s_cmp_eq_u32 s56, 18
    s_cselect_b32 s30, 1024, 0
    s_sub_u32 s41, s41, s30
    s_add_u32 m0, s51, 98304
    s_nop 0
    buffer_load_dwordx4 v4, s[16:19], s43 offen offset:0  lds
    buffer_load_dwordx4 v5, s[16:19], s43 offen offset:1024  lds
    buffer_load_dwordx4 v6, s[16:19], s43 offen offset:2048  lds
    buffer_load_dwordx4 v7, s[16:19], s43 offen offset:3072  lds
    v_bfe_u32 v21, v1, 2, 2
    v_lshrrev_b32 v22, 5, v1
    v_and_b32 v23, 1, v1
    v_bfe_u32 v24, v1, 1, 1
    v_lshl_add_u32 v23, v23, 1, v24
    v_bfe_u32 v24, v1, 4, 1
    v_lshl_add_u32 v25, v22, 3, v21
    v_lshlrev_b32 v25, 10, v25
    v_lshl_add_u32 v25, v24, 5, v25
    v_lshl_add_u32 v25, v23, 3, v25
    s_lshr_b32 s30, s28, 1
    s_lshl_b32 s30, s30, 8
    v_add_u32 v25, s30, v25
    v_xor_b32 v26, 0, v21
    v_lshl_add_u32 v8, v26, 6, v25
    v_xor_b32 v26, 1, v21
    v_lshl_add_u32 v9, v26, 6, v25
    v_xor_b32 v26, 2, v21
    v_lshl_add_u32 v10, v26, 6, v25
    v_xor_b32 v26, 3, v21
    v_lshl_add_u32 v11, v26, 6, v25
    v_add_u32 v17, 0x18000, v8
    v_add_u32 v18, 0x18000, v9
    v_add_u32 v19, 0x18000, v10
    v_add_u32 v20, 0x18000, v11
    v_and_b32 v21, 31, v1
    s_and_b32 s30, s28, 1
    s_lshl_b32 s30, s30, 5
    v_add_u32 v21, s30, v21
    v_bfe_u32 v23, v1, 1, 3
    v_xor_b32 v23, v23, v22
    v_xor_b32 v24, 0, v23
    v_lshlrev_b32 v24, 4, v24
    v_lshl_add_u32 v13, v21, 7, v24
    v_add_u32 v13, 49152, v13
    v_xor_b32 v24, 2, v23
    v_lshlrev_b32 v24, 4, v24
    v_lshl_add_u32 v14, v21, 7, v24
    v_add_u32 v14, 49152, v14
    v_xor_b32 v24, 4, v23
    v_lshlrev_b32 v24, 4, v24
    v_lshl_add_u32 v15, v21, 7, v24
    v_add_u32 v15, 49152, v15
    v_xor_b32 v24, 6, v23
    v_lshlrev_b32 v24, 4, v24
    v_lshl_add_u32 v16, v21, 7, v24
    v_add_u32 v16, 49152, v16
    v_mov_b32 v96, 0
    v_mov_b32 v97, 0
    v_mov_b32 v98, 0
    v_mov_b32 v99, 0
    v_mov_b32 v100, 0
    v_mov_b32 v101, 0
    v_mov_b32 v102, 0
    v_mov_b32 v103, 0
    v_mov_b32 v104, 0
    v_mov_b32 v105, 0
    v_mov_b32 v106, 0
    v_mov_b32 v107, 0
    v_mov_b32 v108, 0
    v_mov_b32 v109, 0
    v_mov_b32 v110, 0
    v_mov_b32 v111, 0
    v_mov_b32 v112, 0
    v_mov_b32 v113, 0
    v_mov_b32 v114, 0
    v_mov_b32 v115, 0
    v_mov_b32 v116, 0
    v_mov_b32 v117, 0
    v_mov_b32 v118, 0
    v_mov_b32 v119, 0
    v_mov_b32 v120, 0
    v_mov_b32 v121, 0
    v_mov_b32 v122, 0
    v_mov_b32 v123, 0
    v_mov_b32 v124, 0
    v_mov_b32 v125, 0
    v_mov_b32 v126, 0
    v_mov_b32 v127, 0
    v_mov_b32 v128, 0
    v_mov_b32 v129, 0
    v_mov_b32 v130, 0
    v_mov_b32 v131, 0
    v_mov_b32 v132, 0
    v_mov_b32 v133, 0
    v_mov_b32 v134, 0
    v_mov_b32 v135, 0
    v_mov_b32 v136, 0
    v_mov_b32 v137, 0
    v_mov_b32 v138, 0
    v_mov_b32 v139, 0
    v_mov_b32 v140, 0
    v_mov_b32 v141, 0
    v_mov_b32 v142, 0
    v_mov_b32 v143, 0
    v_mov_b32 v144, 0
    v_mov_b32 v145, 0
    v_mov_b32 v146, 0
    v_mov_b32 v147, 0
    v_mov_b32 v148, 0
    v_mov_b32 v149, 0
    v_mov_b32 v150, 0
    v_mov_b32 v151, 0
    v_mov_b32 v152, 0
    v_mov_b32 v153, 0
    v_mov_b32 v154, 0
    v_mov_b32 v155, 0
    v_mov_b32 v156, 0
    v_mov_b32 v157, 0
    v_mov_b32 v158, 0
    v_mov_b32 v159, 0
    s_lshl_b32 s43, s45, 18
    s_add_u32 s43, s43, s41
    s_add_u32 s45, s45, 1
    s_cmp_eq_u32 s45, 18
    s_cselect_b32 s45, 0, s45
    s_add_u32 s56, s56, 1
    s_cmp_eq_u32 s56, 18
    s_cselect_b32 s30, 1024, 0
    s_sub_u32 s41, s41, s30
    s_add_u32 m0, s51, 16384
    s_nop 0
    buffer_load_dwordx4 v4, s[16:19], s43 offen offset:0  lds
    buffer_load_dwordx4 v5, s[16:19], s43 offen offset:1024  lds
    buffer_load_dwordx4 v6, s[16:19], s43 offen offset:2048  lds
    buffer_load_dwordx4 v7, s[16:19], s43 offen offset:3072  lds
    s_lshl_b32 s44, s46, 7
    s_add_u32 s44, s44, s42
    s_add_u32 s46, s46, 1
    s_cmp_eq_u32 s46, 9
    s_cselect_b32 s46, 0, s46
    s_add_u32 m0, s52, 57344
    s_nop 0
    buffer_load_dwordx4 v12, s[4:7], s44 offen  lds
    s_waitcnt vmcnt(5)
    s_barrier
    ds_read_b128 v[192:195], v13 offset:0
    ds_read_b64_tr_b16 v[160:161], v17 offset:0
    ds_read_b64_tr_b16 v[162:163], v17 offset:4096
    ds_read_b64_tr_b16 v[164:165], v18 offset:0
    ds_read_b64_tr_b16 v[166:167], v18 offset:4096
    ds_read_b64_tr_b16 v[168:169], v19 offset:0
    ds_read_b64_tr_b16 v[170:171], v19 offset:4096
    ds_read_b64_tr_b16 v[172:173], v20 offset:0
    ds_read_b64_tr_b16 v[174:175], v20 offset:4096
    s_lshl_b32 s43, s45, 18
    s_add_u32 s43, s43, s41
    s_add_u32 s45, s45, 1
    s_cmp_eq_u32 s45, 18
    s_cselect_b32 s45, 0, s45
    s_add_u32 s56, s56, 1
    s_cmp_eq_u32 s56, 18
    s_cselect_b32 s30, 1024, 0
    s_sub_u32 s41, s41, s30
    s_add_u32 m0, s51, 131072
    s_nop 0
    buffer_load_dwordx4 v4, s[16:19], s43 offen offset:0  lds
    buffer_load_dwordx4 v5, s[16:19], s43 offen offset:1024  lds
    buffer_load_dwordx4 v6, s[16:19], s43 offen offset:2048  lds
    buffer_load_dwordx4 v7, s[16:19], s43 offen offset:3072  lds
    s_mov_b32 s36, 0
LF_Qloop:
    s_waitcnt lgkmcnt(6)
    v_mfma_f32_32x32x16_bf16 v[96:111], v[160:163], v[192:195], v[96:111]
    ds_read_b128 v[196:199], v14 offset:0
    ds_read_b64_tr_b16 v[176:177], v17 offset:16384
    ds_read_b64_tr_b16 v[178:179], v17 offset:20480
    s_waitcnt lgkmcnt(7)
    v_mfma_f32_32x32x16_bf16 v[112:127], v[164:167], v[192:195], v[112:127]
    ds_read_b64_tr_b16 v[180:181], v18 offset:16384
    ds_read_b64_tr_b16 v[182:183], v18 offset:20480
    ds_read_b64_tr_b16 v[184:185], v19 offset:16384
    ds_read_b64_tr_b16 v[186:187], v19 offset:20480
    s_waitcnt lgkmcnt(9)
    v_mfma_f32_32x32x16_bf16 v[128:143], v[168:171], v[192:195], v[128:143]
    ds_read_b64_tr_b16 v[188:189], v20 offset:16384
    ds_read_b64_tr_b16 v[190:191], v20 offset:20480
    s_waitcnt lgkmcnt(9)
    v_mfma_f32_32x32x16_bf16 v[144:159], v[172:175], v[192:195], v[144:159]
    s_waitcnt vmcnt(4) lgkmcnt(0)
    s_barrier
    v_mfma_f32_32x32x16_bf16 v[96:111], v[176:179], v[196:199], v[96:111]
    ds_read_b128 v[192:195], v15 offset:0
    ds_read_b64_tr_b16 v[160:161], v8 offset:16384
    ds_read_b64_tr_b16 v[162:163], v8 offset:20480
    v_mfma_f32_32x32x16_bf16 v[112:127], v[180:183], v[196:199], v[112:127]
    ds_read_b64_tr_b16 v[164:165], v9 offset:16384
    ds_read_b64_tr_b16 v[166:167], v9 offset:20480
    ds_read_b64_tr_b16 v[168:169], v10 offset:16384
    ds_read_b64_tr_b16 v[170:171], v10 offset:20480
    s_lshl_b32 s43, s45, 18
    s_add_u32 s43, s43, s41
    s_add_u32 s45, s45, 1
    s_cmp_eq_u32 s45, 18
    s_cselect_b32 s45, 0, s45
    s_add_u32 s56, s56, 1
    s_cmp_eq_u32 s56, 18
    s_cselect_b32 s30, 1024, 0
    s_sub_u32 s41, s41, s30
    s_add_u32 m0, s51, 98304
    s_nop 0
    buffer_load_dwordx4 v4, s[16:19], s43 offen offset:0  lds
    v_mfma_f32_32x32x16_bf16 v[128:143], v[184:187], v[196:199], v[128:143]
    ds_read_b64_tr_b16 v[172:173], v11 offset:16384
    ds_read_b64_tr_b16 v[174:175], v11 offset:20480
    buffer_load_dwordx4 v5, s[16:19], s43 offen offset:1024  lds
    v_mfma_f32_32x32x16_bf16 v[144:159], v[188:191], v[196:199], v[144:159]
    buffer_load_dwordx4 v6, s[16:19], s43 offen offset:2048  lds
    s_waitcnt lgkmcnt(6)
    v_mfma_f32_32x32x16_bf16 v[96:111], v[160:163], v[192:195], v[96:111]
    ds_read_b128 v[196:199], v16 offset:0
    ds_read_b64_tr_b16 v[176:177], v8 offset:32768
    ds_read_b64_tr_b16 v[178:179], v8 offset:36864
    s_waitcnt lgkmcnt(7)
    v_mfma_f32_32x32x16_bf16 v[112:127], v[164:167], v[192:195], v[112:127]
    ds_read_b64_tr_b16 v[180:181], v9 offset:32768
    ds_read_b64_tr_b16 v[182:183], v9 offset:36864
    ds_read_b64_tr_b16 v[184:185], v10 offset:32768
    ds_read_b64_tr_b16 v[186:187], v10 offset:36864
    buffer_load_dwordx4 v7, s[16:19], s43 offen offset:3072  lds
    s_waitcnt lgkmcnt(9)
    v_mfma_f32_32x32x16_bf16 v[128:143], v[168:171], v[192:195], v[128:143]
    ds_read_b64_tr_b16 v[188:189], v11 offset:32768
    ds_read_b64_tr_b16 v[190:191], v11 offset:36864
    s_lshl_b32 s44, s46, 7
    s_add_u32 s44, s44, s42
    s_add_u32 s46, s46, 1
    s_cmp_eq_u32 s46, 9
    s_cselect_b32 s46, 0, s46
    s_add_u32 m0, s52, 81920
    s_nop 0
    buffer_load_dwordx4 v12, s[4:7], s44 offen  lds
    s_waitcnt lgkmcnt(9)
    v_mfma_f32_32x32x16_bf16 v[144:159], v[172:175], v[192:195], v[144:159]
    s_waitcnt vmcnt(5) lgkmcnt(0)
    s_barrier
    v_mfma_f32_32x32x16_bf16 v[96:111], v[176:179], v[196:199], v[96:111]
    ds_read_b128 v[192:195], v13 offset:8192
    ds_read_b64_tr_b16 v[160:161], v17 offset:32768
    ds_read_b64_tr_b16 v[162:163], v17 offset:36864
    v_mfma_f32_32x32x16_bf16 v[112:127], v[180:183], v[196:199], v[112:127]
    ds_read_b64_tr_b16 v[164:165], v18 offset:32768
    ds_read_b64_tr_b16 v[166:167], v18 offset:36864
    ds_read_b64_tr_b16 v[168:169], v19 offset:32768
    ds_read_b64_tr_b16 v[170:171], v19 offset:36864
    s_lshl_b32 s43, s45, 18
    s_add_u32 s43, s43, s41
    s_add_u32 s45, s45, 1
    s_cmp_eq_u32 s45, 18
    s_cselect_b32 s45, 0, s45
    s_add_u32 s56, s56, 1
    s_cmp_eq_u32 s56, 18
    s_cselect_b32 s30, 1024, 0
    s_sub_u32 s41, s41, s30
    s_add_u32 m0, s51, 16384
    s_nop 0
    buffer_load_dwordx4 v4, s[16:19], s43 offen offset:0  lds
    v_mfma_f32_32x32x16_bf16 v[128:143], v[184:187], v[196:199], v[128:143]
    ds_read_b64_tr_b16 v[172:173], v20 offset:32768
    ds_read_b64_tr_b16 v[174:175], v20 offset:36864
    buffer_load_dwordx4 v5, s[16:19], s43 offen offset:1024  lds
    v_mfma_f32_32x32x16_bf16 v[144:159], v[188:191], v[196:199], v[144:159]
    buffer_load_dwordx4 v6, s[16:19], s43 offen offset:2048  lds
    s_waitcnt lgkmcnt(6)
    v_mfma_f32_32x32x16_bf16 v[96:111], v[160:163], v[192:195], v[96:111]
    ds_read_b128 v[196:199], v14 offset:8192
    ds_read_b64_tr_b16 v[176:177], v17 offset:49152
    ds_read_b64_tr_b16 v[178:179], v17 offset:53248
    s_waitcnt lgkmcnt(7)
    v_mfma_f32_32x32x16_bf16 v[112:127], v[164:167], v[192:195], v[112:127]
    ds_read_b64_tr_b16 v[180:181], v18 offset:49152
    ds_read_b64_tr_b16 v[182:183], v18 offset:53248
    ds_read_b64_tr_b16 v[184:185], v19 offset:49152
    ds_read_b64_tr_b16 v[186:187], v19 offset:53248
    buffer_load_dwordx4 v7, s[16:19], s43 offen offset:3072  lds
    s_waitcnt lgkmcnt(9)
    v_mfma_f32_32x32x16_bf16 v[128:143], v[168:171], v[192:195], v[128:143]
    ds_read_b64_tr_b16 v[188:189], v20 offset:49152
    ds_read_b64_tr_b16 v[190:191], v20 offset:53248
    s_waitcnt lgkmcnt(9)
    v_mfma_f32_32x32x16_bf16 v[144:159], v[172:175], v[192:195], v[144:159]
    s_waitcnt vmcnt(4) lgkmcnt(0)
    s_barrier
    v_mfma_f32_32x32x16_bf16 v[96:111], v[176:179], v[196:199], v[96:111]
    ds_read_b128 v[192:195], v15 offset:8192
    ds_read_b64_tr_b16 v[160:161], v17 offset:0
    ds_read_b64_tr_b16 v[162:163], v17 offset:4096
    v_mfma_f32_32x32x16_bf16 v[112:127], v[180:183], v[196:199], v[112:127]
    ds_read_b64_tr_b16 v[164:165], v18 offset:0
    ds_read_b64_tr_b16 v[166:167], v18 offset:4096
    ds_read_b64_tr_b16 v[168:169], v19 offset:0
    ds_read_b64_tr_b16 v[170:171], v19 offset:4096
    s_lshl_b32 s43, s45, 18
    s_add_u32 s43, s43, s41
    s_add_u32 s45, s45, 1
    s_cmp_eq_u32 s45, 18
    s_cselect_b32 s45, 0, s45
    s_add_u32 s56, s56, 1
    s_cmp_eq_u32 s56, 18
    s_cselect_b32 s30, 1024, 0
    s_sub_u32 s41, s41, s30
    s_add_u32 m0, s51, 131072
    s_nop 0
    buffer_load_dwordx4 v4, s[16:19], s43 offen offset:0  lds
    v_mfma_f32_32x32x16_bf16 v[128:143], v[184:187], v[196:199], v[128:143]
    ds_read_b64_tr_b16 v[172:173], v20 offset:0
    ds_read_b64_tr_b16 v[174:175], v20 offset:4096
    buffer_load_dwordx4 v5, s[16:19], s43 offen offset:1024  lds
    v_mfma_f32_32x32x16_bf16 v[144:159], v[188:191], v[196:199], v[144:159]
    buffer_load_dwordx4 v6, s[16:19], s43 offen offset:2048  lds
    s_waitcnt lgkmcnt(6)
    v_mfma_f32_32x32x16_bf16 v[96:111], v[160:163], v[192:195], v[96:111]
    ds_read_b128 v[196:199], v16 offset:8192
    ds_read_b64_tr_b16 v[176:177], v17 offset:16384
    ds_read_b64_tr_b16 v[178:179], v17 offset:20480
    s_waitcnt lgkmcnt(7)
    v_mfma_f32_32x32x16_bf16 v[112:127], v[164:167], v[192:195], v[112:127]
    ds_read_b64_tr_b16 v[180:181], v18 offset:16384
    ds_read_b64_tr_b16 v[182:183], v18 offset:20480
    ds_read_b64_tr_b16 v[184:185], v19 offset:16384
    ds_read_b64_tr_b16 v[186:187], v19 offset:20480
    buffer_load_dwordx4 v7, s[16:19], s43 offen offset:3072  lds
    s_waitcnt lgkmcnt(9)
    v_mfma_f32_32x32x16_bf16 v[128:143], v[168:171], v[192:195], v[128:143]
    ds_read_b64_tr_b16 v[188:189], v20 offset:16384
    ds_read_b64_tr_b16 v[190:191], v20 offset:20480
    s_lshl_b32 s44, s46, 7
    s_add_u32 s44, s44, s42
    s_add_u32 s46, s46, 1
    s_cmp_eq_u32 s46, 9
    s_cselect_b32 s46, 0, s46
    s_add_u32 m0, s52, 49152
    s_nop 0
    buffer_load_dwordx4 v12, s[4:7], s44 offen  lds
    s_waitcnt lgkmcnt(9)
    v_mfma_f32_32x32x16_bf16 v[144:159], v[172:175], v[192:195], v[144:159]
    s_waitcnt vmcnt(5) lgkmcnt(0)
    s_barrier
    v_mfma_f32_32x32x16_bf16 v[96:111], v[176:179], v[196:199], v[96:111]
    ds_read_b128 v[192:195], v13 offset:32768
    ds_read_b64_tr_b16 v[160:161], v8 offset:16384
    ds_read_b64_tr_b16 v[162:163], v8 offset:20480
    v_mfma_f32_32x32x16_bf16 v[112:127], v[180:183], v[196:199], v[112:127]
    ds_read_b64_tr_b16 v[164:165], v9 offset:16384
    ds_read_b64_tr_b16 v[166:167], v9 offset:20480
    ds_read_b64_tr_b16 v[168:169], v10 offset:16384
    ds_read_b64_tr_b16 v[170:171], v10 offset:20480
    s_lshl_b32 s43, s45, 18
    s_add_u32 s43, s43, s41
    s_add_u32 s45, s45, 1
    s_cmp_eq_u32 s45, 18
    s_cselect_b32 s45, 0, s45
    s_add_u32 s56, s56, 1
    s_cmp_eq_u32 s56, 18
    s_cselect_b32 s30, 1024, 0
    s_sub_u32 s41, s41, s30
    s_add_u32 m0, s51, 98304
    s_nop 0
    buffer_load_dwordx4 v4, s[16:19], s43 offen offset:0  lds
    v_mfma_f32_32x32x16_bf16 v[128:143], v[184:187], v[196:199], v[128:143]
    ds_read_b64_tr_b16 v[172:173], v11 offset:16384
    ds_read_b64_tr_b16 v[174:175], v11 offset:20480
    buffer_load_dwordx4 v5, s[16:19], s43 offen offset:1024  lds
    v_mfma_f32_32x32x16_bf16 v[144:159], v[188:191], v[196:199], v[144:159]
    buffer_load_dwordx4 v6, s[16:19], s43 offen offset:2048  lds
    s_waitcnt lgkmcnt(6)
    v_mfma_f32_32x32x16_bf16 v[96:111], v[160:163], v[192:195], v[96:111]
    ds_read_b128 v[196:199], v14 offset:32768
    ds_read_b64_tr_b16 v[176:177], v8 offset:32768
    ds_read_b64_tr_b16 v[178:179], v8 offset:36864
    s_waitcnt lgkmcnt(7)
    v_mfma_f32_32x32x16_bf16 v[112:127], v[164:167], v[192:195], v[112:127]
    ds_read_b64_tr_b16 v[180:181], v9 offset:32768
    ds_read_b64_tr_b16 v[182:183], v9 offset:36864
    ds_read_b64_tr_b16 v[184:185], v10 offset:32768
    ds_read_b64_tr_b16 v[186:187], v10 offset:36864
    buffer_load_dwordx4 v7, s[16:19], s43 offen offset:3072  lds
    s_waitcnt lgkmcnt(9)
    v_mfma_f32_32x32x16_bf16 v[128:143], v[168:171], v[192:195], v[128:143]
    ds_read_b64_tr_b16 v[188:189], v11 offset:32768
    ds_read_b64_tr_b16 v[190:191], v11 offset:36864
    s_waitcnt lgkmcnt(9)
    v_mfma_f32_32x32x16_bf16 v[144:159], v[172:175], v[192:195], v[144:159]
    s_waitcnt vmcnt(4) lgkmcnt(0)
    s_barrier
    v_mfma_f32_32x32x16_bf16 v[96:111], v[176:179], v[196:199], v[96:111]
    ds_read_b128 v[192:195], v15 offset:32768
    ds_read_b64_tr_b16 v[160:161], v17 offset:32768
    ds_read_b64_tr_b16 v[162:163], v17 offset:36864
    v_mfma_f32_32x32x16_bf16 v[112:127], v[180:183], v[196:199], v[112:127]
    ds_read_b64_tr_b16 v[164:165], v18 offset:32768
    ds_read_b64_tr_b16 v[166:167], v18 offset:36864
    ds_read_b64_tr_b16 v[168:169], v19 offset:32768
    ds_read_b64_tr_b16 v[170:171], v19 offset:36864
    s_lshl_b32 s43, s45, 18
    s_add_u32 s43, s43, s41
    s_add_u32 s45, s45, 1
    s_cmp_eq_u32 s45, 18
    s_cselect_b32 s45, 0, s45
    s_add_u32 s56, s56, 1
    s_cmp_eq_u32 s56, 18
    s_cselect_b32 s30, 1024, 0
    s_sub_u32 s41, s41, s30
    s_add_u32 m0, s51, 16384
    s_nop 0
    buffer_load_dwordx4 v4, s[16:19], s43 offen offset:0  lds
    v_mfma_f32_32x32x16_bf16 v[128:143], v[184:187], v[196:199], v[128:143]
    ds_read_b64_tr_b16 v[172:173], v20 offset:32768
    ds_read_b64_tr_b16 v[174:175], v20 offset:36864
    buffer_load_dwordx4 v5, s[16:19], s43 offen offset:1024  lds
    v_mfma_f32_32x32x16_bf16 v[144:159], v[188:191], v[196:199], v[144:159]
    buffer_load_dwordx4 v6, s[16:19], s43 offen offset:2048  lds
    s_waitcnt lgkmcnt(6)
    v_mfma_f32_32x32x16_bf16 v[96:111], v[160:163], v[192:195], v[96:111]
    ds_read_b128 v[196:199], v16 offset:32768
    ds_read_b64_tr_b16 v[176:177], v17 offset:49152
    ds_read_b64_tr_b16 v[178:179], v17 offset:53248
    s_waitcnt lgkmcnt(7)
    v_mfma_f32_32x32x16_bf16 v[112:127], v[164:167], v[192:195], v[112:127]
    ds_read_b64_tr_b16 v[180:181], v18 offset:49152
    ds_read_b64_tr_b16 v[182:183], v18 offset:53248
    ds_read_b64_tr_b16 v[184:185], v19 offset:49152
    ds_read_b64_tr_b16 v[186:187], v19 offset:53248
    buffer_load_dwordx4 v7, s[16:19], s43 offen offset:3072  lds
    s_waitcnt lgkmcnt(9)
    v_mfma_f32_32x32x16_bf16 v[128:143], v[168:171], v[192:195], v[128:143]
    ds_read_b64_tr_b16 v[188:189], v20 offset:49152
    ds_read_b64_tr_b16 v[190:191], v20 offset:53248
    s_lshl_b32 s44, s46, 7
    s_add_u32 s44, s44, s42
    s_add_u32 s46, s46, 1
    s_cmp_eq_u32 s46, 9
    s_cselect_b32 s46, 0, s46
    s_add_u32 m0, s52, 57344
    s_nop 0
    buffer_load_dwordx4 v12, s[4:7], s44 offen  lds
    s_waitcnt lgkmcnt(9)
    v_mfma_f32_32x32x16_bf16 v[144:159], v[172:175], v[192:195], v[144:159]
    s_waitcnt vmcnt(5) lgkmcnt(0)
    s_barrier
    v_mfma_f32_32x32x16_bf16 v[96:111], v[176:179], v[196:199], v[96:111]
    ds_read_b128 v[192:195], v13 offset:0
    ds_read_b64_tr_b16 v[160:161], v17 offset:0
    ds_read_b64_tr_b16 v[162:163], v17 offset:4096
    v_mfma_f32_32x32x16_bf16 v[112:127], v[180:183], v[196:199], v[112:127]
    ds_read_b64_tr_b16 v[164:165], v18 offset:0
    ds_read_b64_tr_b16 v[166:167], v18 offset:4096
    ds_read_b64_tr_b16 v[168:169], v19 offset:0
    ds_read_b64_tr_b16 v[170:171], v19 offset:4096
    s_lshl_b32 s43, s45, 18
    s_add_u32 s43, s43, s41
    s_add_u32 s45, s45, 1
    s_cmp_eq_u32 s45, 18
    s_cselect_b32 s45, 0, s45
    s_add_u32 s56, s56, 1
    s_cmp_eq_u32 s56, 18
    s_cselect_b32 s30, 1024, 0
    s_sub_u32 s41, s41, s30
    s_add_u32 m0, s51, 131072
    s_nop 0
    buffer_load_dwordx4 v4, s[16:19], s43 offen offset:0  lds
    v_mfma_f32_32x32x16_bf16 v[128:143], v[184:187], v[196:199], v[128:143]
    ds_read_b64_tr_b16 v[172:173], v20 offset:0
    ds_read_b64_tr_b16 v[174:175], v20 offset:4096
    buffer_load_dwordx4 v5, s[16:19], s43 offen offset:1024  lds
    v_mfma_f32_32x32x16_bf16 v[144:159], v[188:191], v[196:199], v[144:159]
    buffer_load_dwordx4 v6, s[16:19], s43 offen offset:2048  lds
    buffer_load_dwordx4 v7, s[16:19], s43 offen offset:3072  lds
    s_add_u32 s36, s36, 1
    s_cmp_lg_u32 s36, 3
    s_cbranch_scc1 LF_Q_nomid
    v_mul_f32 v96, s33, v96
    v_mul_f32 v97, s33, v97
    v_mul_f32 v98, s33, v98
    v_mul_f32 v99, s33, v99
    v_mul_f32 v100, s33, v100
    v_mul_f32 v101, s33, v101
    v_mul_f32 v102, s33, v102
    v_mul_f32 v103, s33, v103
    v_mul_f32 v104, s33, v104
    v_mul_f32 v105, s33, v105
    v_mul_f32 v106, s33, v106
    v_mul_f32 v107, s33, v107
    v_mul_f32 v108, s33, v108
    v_mul_f32 v109, s33, v109
    v_mul_f32 v110, s33, v110
    v_mul_f32 v111, s33, v111
    v_mul_f32 v112, s33, v112
    v_mul_f32 v113, s33, v113
    v_mul_f32 v114, s33, v114
    v_mul_f32 v115, s33, v115
    v_mul_f32 v116, s33, v116
    v_mul_f32 v117, s33, v117
    v_mul_f32 v118, s33, v118
    v_mul_f32 v119, s33, v119
    v_mul_f32 v120, s33, v120
    v_mul_f32 v121, s33, v121
    v_mul_f32 v122, s33, v122
    v_mul_f32 v123, s33, v123
    v_mul_f32 v124, s33, v124
    v_mul_f32 v125, s33, v125
    v_mul_f32 v126, s33, v126
    v_mul_f32 v127, s33, v127
    v_mul_f32 v128, s33, v128
    v_mul_f32 v129, s33, v129
    v_mul_f32 v130, s33, v130
    v_mul_f32 v131, s33, v131
    v_mul_f32 v132, s33, v132
    v_mul_f32 v133, s33, v133
    v_mul_f32 v134, s33, v134
    v_mul_f32 v135, s33, v135
    v_mul_f32 v136, s33, v136
    v_mul_f32 v137, s33, v137
    v_mul_f32 v138, s33, v138
    v_mul_f32 v139, s33, v139
    v_mul_f32 v140, s33, v140
    v_mul_f32 v141, s33, v141
    v_mul_f32 v142, s33, v142
    v_mul_f32 v143, s33, v143
    v_mul_f32 v144, s33, v144
    v_mul_f32 v145, s33, v145
    v_mul_f32 v146, s33, v146
    v_mul_f32 v147, s33, v147
    v_mul_f32 v148, s33, v148
    v_mul_f32 v149, s33, v149
    v_mul_f32 v150, s33, v150
    v_mul_f32 v151, s33, v151
    v_mul_f32 v152, s33, v152
    v_mul_f32 v153, s33, v153
    v_mul_f32 v154, s33, v154
    v_mul_f32 v155, s33, v155
    v_mul_f32 v156, s33, v156
    v_mul_f32 v157, s33, v157
    v_mul_f32 v158, s33, v158
    v_mul_f32 v159, s33, v159
    v_cvt_pk_bf16_f32 v64, v96, v97
    v_cvt_pk_bf16_f32 v65, v98, v99
    v_cvt_pk_bf16_f32 v66, v100, v101
    v_cvt_pk_bf16_f32 v67, v102, v103
    v_cvt_pk_bf16_f32 v68, v104, v105
    v_cvt_pk_bf16_f32 v69, v106, v107
    v_cvt_pk_bf16_f32 v70, v108, v109
    v_cvt_pk_bf16_f32 v71, v110, v111
    v_cvt_pk_bf16_f32 v72, v112, v113
    v_cvt_pk_bf16_f32 v73, v114, v115
    v_cvt_pk_bf16_f32 v74, v116, v117
    v_cvt_pk_bf16_f32 v75, v118, v119
    v_cvt_pk_bf16_f32 v76, v120, v121
    v_cvt_pk_bf16_f32 v77, v122, v123
    v_cvt_pk_bf16_f32 v78, v124, v125
    v_cvt_pk_bf16_f32 v79, v126, v127
    v_cvt_pk_bf16_f32 v80, v128, v129
    v_cvt_pk_bf16_f32 v81, v130, v131
    v_cvt_pk_bf16_f32 v82, v132, v133
    v_cvt_pk_bf16_f32 v83, v134, v135
    v_cvt_pk_bf16_f32 v84, v136, v137
    v_cvt_pk_bf16_f32 v85, v138, v139
    v_cvt_pk_bf16_f32 v86, v140, v141
    v_cvt_pk_bf16_f32 v87, v142, v143
    v_cvt_pk_bf16_f32 v88, v144, v145
    v_cvt_pk_bf16_f32 v89, v146, v147
    v_cvt_pk_bf16_f32 v90, v148, v149
    v_cvt_pk_bf16_f32 v91, v150, v151
    v_cvt_pk_bf16_f32 v92, v152, v153
    v_cvt_pk_bf16_f32 v93, v154, v155
    v_cvt_pk_bf16_f32 v94, v156, v157
    v_cvt_pk_bf16_f32 v95, v158, v159
    v_mov_b32 v96, 0
    v_mov_b32 v97, 0
    v_mov_b32 v98, 0
    v_mov_b32 v99, 0
    v_mov_b32 v100, 0
    v_mov_b32 v101, 0
    v_mov_b32 v102, 0
    v_mov_b32 v103, 0
    v_mov_b32 v104, 0
    v_mov_b32 v105, 0
    v_mov_b32 v106, 0
    v_mov_b32 v107, 0
    v_mov_b32 v108, 0
    v_mov_b32 v109, 0
    v_mov_b32 v110, 0
    v_mov_b32 v111, 0
    v_mov_b32 v112, 0
    v_mov_b32 v113, 0
    v_mov_b32 v114, 0
    v_mov_b32 v115, 0
    v_mov_b32 v116, 0
    v_mov_b32 v117, 0
    v_mov_b32 v118, 0
    v_mov_b32 v119, 0
    v_mov_b32 v120, 0
    v_mov_b32 v121, 0
    v_mov_b32 v122, 0
    v_mov_b32 v123, 0
    v_mov_b32 v124, 0
    v_mov_b32 v125, 0
    v_mov_b32 v126, 0
    v_mov_b32 v127, 0
    v_mov_b32 v128, 0
    v_mov_b32 v129, 0
    v_mov_b32 v130, 0
    v_mov_b32 v131, 0
    v_mov_b32 v132, 0
    v_mov_b32 v133, 0
    v_mov_b32 v134, 0
    v_mov_b32 v135, 0
    v_mov_b32 v136, 0
    v_mov_b32 v137, 0
    v_mov_b32 v138, 0
    v_mov_b32 v139, 0
    v_mov_b32 v140, 0
    v_mov_b32 v141, 0
    v_mov_b32 v142, 0
    v_mov_b32 v143, 0
    v_mov_b32 v144, 0
    v_mov_b32 v145, 0
    v_mov_b32 v146, 0
    v_mov_b32 v147, 0
    v_mov_b32 v148, 0
    v_mov_b32 v149, 0
    v_mov_b32 v150, 0
    v_mov_b32 v151, 0
    v_mov_b32 v152, 0
    v_mov_b32 v153, 0
    v_mov_b32 v154, 0
    v_mov_b32 v155, 0
    v_mov_b32 v156, 0
    v_mov_b32 v157, 0
    v_mov_b32 v158, 0
    v_mov_b32 v159, 0
LF_Q_nomid:
    s_cmp_lt_u32 s36, 5
    s_cbranch_scc1 LF_Qloop
    s_waitcnt lgkmcnt(6)
    v_mfma_f32_32x32x16_bf16 v[96:111], v[160:163], v[192:195], v[96:111]
    ds_read_b128 v[196:199], v14 offset:0
    ds_read_b64_tr_b16 v[176:177], v17 offset:16384
    ds_read_b64_tr_b16 v[178:179], v17 offset:20480
    s_waitcnt lgkmcnt(7)
    v_mfma_f32_32x32x16_bf16 v[112:127], v[164:167], v[192:195], v[112:127]
    ds_read_b64_tr_b16 v[180:181], v18 offset:16384
    ds_read_b64_tr_b16 v[182:183], v18 offset:20480
    ds_read_b64_tr_b16 v[184:185], v19 offset:16384
    ds_read_b64_tr_b16 v[186:187], v19 offset:20480
    s_waitcnt lgkmcnt(9)
    v_mfma_f32_32x32x16_bf16 v[128:143], v[168:171], v[192:195], v[128:143]
    ds_read_b64_tr_b16 v[188:189], v20 offset:16384
    ds_read_b64_tr_b16 v[190:191], v20 offset:20480
    s_waitcnt lgkmcnt(9)
    v_mfma_f32_32x32x16_bf16 v[144:159], v[172:175], v[192:195], v[144:159]
    s_waitcnt vmcnt(4) lgkmcnt(0)
    s_barrier
    v_mfma_f32_32x32x16_bf16 v[96:111], v[176:179], v[196:199], v[96:111]
    ds_read_b128 v[192:195], v15 offset:0
    ds_read_b64_tr_b16 v[160:161], v8 offset:16384
    ds_read_b64_tr_b16 v[162:163], v8 offset:20480
    v_mfma_f32_32x32x16_bf16 v[112:127], v[180:183], v[196:199], v[112:127]
    ds_read_b64_tr_b16 v[164:165], v9 offset:16384
    ds_read_b64_tr_b16 v[166:167], v9 offset:20480
    ds_read_b64_tr_b16 v[168:169], v10 offset:16384
    ds_read_b64_tr_b16 v[170:171], v10 offset:20480
    s_lshl_b32 s43, s45, 18
    s_add_u32 s43, s43, s41
    s_add_u32 s45, s45, 1
    s_cmp_eq_u32 s45, 18
    s_cselect_b32 s45, 0, s45
    s_add_u32 s56, s56, 1
    s_cmp_eq_u32 s56, 18
    s_cselect_b32 s30, 1024, 0
    s_sub_u32 s41, s41, s30
    s_add_u32 m0, s51, 98304
    s_nop 0
    buffer_load_dwordx4 v4, s[16:19], s43 offen offset:0  lds
    v_mfma_f32_32x32x16_bf16 v[128:143], v[184:187], v[196:199], v[128:143]
    ds_read_b64_tr_b16 v[172:173], v11 offset:16384
    ds_read_b64_tr_b16 v[174:175], v11 offset:20480
    buffer_load_dwordx4 v5, s[16:19], s43 offen offset:1024  lds
    v_mfma_f32_32x32x16_bf16 v[144:159], v[188:191], v[196:199], v[144:159]
    buffer_load_dwordx4 v6, s[16:19], s43 offen offset:2048  lds
    s_waitcnt lgkmcnt(6)
    v_mfma_f32_32x32x16_bf16 v[96:111], v[160:163], v[192:195], v[96:111]
    ds_read_b128 v[196:199], v16 offset:0
    ds_read_b64_tr_b16 v[176:177], v8 offset:32768
    ds_read_b64_tr_b16 v[178:179], v8 offset:36864
    s_waitcnt lgkmcnt(7)
    v_mfma_f32_32x32x16_bf16 v[112:127], v[164:167], v[192:195], v[112:127]
    ds_read_b64_tr_b16 v[180:181], v9 offset:32768
    ds_read_b64_tr_b16 v[182:183], v9 offset:36864
    ds_read_b64_tr_b16 v[184:185], v10 offset:32768
    ds_read_b64_tr_b16 v[186:187], v10 offset:36864
    buffer_load_dwordx4 v7, s[16:19], s43 offen offset:3072  lds
    s_waitcnt lgkmcnt(9)
    v_mfma_f32_32x32x16_bf16 v[128:143], v[168:171], v[192:195], v[128:143]
    ds_read_b64_tr_b16 v[188:189], v11 offset:32768
    ds_read_b64_tr_b16 v[190:191], v11 offset:36864
    s_lshl_b32 s44, s46, 7
    s_add_u32 s44, s44, s42
    s_add_u32 s46, s46, 1
    s_cmp_eq_u32 s46, 9
    s_cselect_b32 s46, 0, s46
    s_add_u32 m0, s52, 81920
    s_nop 0
    buffer_load_dwordx4 v12, s[4:7], s44 offen  lds
    s_waitcnt lgkmcnt(9)
    v_mfma_f32_32x32x16_bf16 v[144:159], v[172:175], v[192:195], v[144:159]
    s_waitcnt vmcnt(5) lgkmcnt(0)
    s_barrier
    v_mfma_f32_32x32x16_bf16 v[96:111], v[176:179], v[196:199], v[96:111]
    ds_read_b128 v[192:195], v13 offset:8192
    ds_read_b64_tr_b16 v[160:161], v17 offset:32768
    ds_read_b64_tr_b16 v[162:163], v17 offset:36864
    v_mfma_f32_32x32x16_bf16 v[112:127], v[180:183], v[196:199], v[112:127]
    ds_read_b64_tr_b16 v[164:165], v18 offset:32768
    ds_read_b64_tr_b16 v[166:167], v18 offset:36864
    ds_read_b64_tr_b16 v[168:169], v19 offset:32768
    ds_read_b64_tr_b16 v[170:171], v19 offset:36864
    s_lshl_b32 s43, s45, 18
    s_add_u32 s43, s43, s41
    s_add_u32 s45, s45, 1
    s_cmp_eq_u32 s45, 18
    s_cselect_b32 s45, 0, s45
    s_add_u32 s56, s56, 1
    s_cmp_eq_u32 s56, 18
    s_cselect_b32 s30, 1024, 0
    s_sub_u32 s41, s41, s30
    s_add_u32 m0, s51, 16384
    s_nop 0
    buffer_load_dwordx4 v4, s[16:19], s43 offen offset:0  lds
    v_mfma_f32_32x32x16_bf16 v[128:143], v[184:187], v[196:199], v[128:143]
    ds_read_b64_tr_b16 v[172:173], v20 offset:32768
    ds_read_b64_tr_b16 v[174:175], v20 offset:36864
    buffer_load_dwordx4 v5, s[16:19], s43 offen offset:1024  lds
    v_mfma_f32_32x32x16_bf16 v[144:159], v[188:191], v[196:199], v[144:159]
    buffer_load_dwordx4 v6, s[16:19], s43 offen offset:2048  lds
    s_waitcnt lgkmcnt(6)
    v_mfma_f32_32x32x16_bf16 v[96:111], v[160:163], v[192:195], v[96:111]
    ds_read_b128 v[196:199], v14 offset:8192
    ds_read_b64_tr_b16 v[176:177], v17 offset:49152
    ds_read_b64_tr_b16 v[178:179], v17 offset:53248
    s_waitcnt lgkmcnt(7)
    v_mfma_f32_32x32x16_bf16 v[112:127], v[164:167], v[192:195], v[112:127]
    ds_read_b64_tr_b16 v[180:181], v18 offset:49152
    ds_read_b64_tr_b16 v[182:183], v18 offset:53248
    ds_read_b64_tr_b16 v[184:185], v19 offset:49152
    ds_read_b64_tr_b16 v[186:187], v19 offset:53248
    buffer_load_dwordx4 v7, s[16:19], s43 offen offset:3072  lds
    s_waitcnt lgkmcnt(9)
    v_mfma_f32_32x32x16_bf16 v[128:143], v[168:171], v[192:195], v[128:143]
    ds_read_b64_tr_b16 v[188:189], v20 offset:49152
    ds_read_b64_tr_b16 v[190:191], v20 offset:53248
    s_waitcnt lgkmcnt(9)
    v_mfma_f32_32x32x16_bf16 v[144:159], v[172:175], v[192:195], v[144:159]
    s_waitcnt vmcnt(4) lgkmcnt(0)
    s_barrier
    v_mfma_f32_32x32x16_bf16 v[96:111], v[176:179], v[196:199], v[96:111]
    ds_read_b128 v[192:195], v15 offset:8192
    ds_read_b64_tr_b16 v[160:161], v17 offset:0
    ds_read_b64_tr_b16 v[162:163], v17 offset:4096
    v_mfma_f32_32x32x16_bf16 v[112:127], v[180:183], v[196:199], v[112:127]
    ds_read_b64_tr_b16 v[164:165], v18 offset:0
    ds_read_b64_tr_b16 v[166:167], v18 offset:4096
    ds_read_b64_tr_b16 v[168:169], v19 offset:0
    ds_read_b64_tr_b16 v[170:171], v19 offset:4096
    s_lshl_b32 s43, s45, 18
    s_add_u32 s43, s43, s41
    s_add_u32 s45, s45, 1
    s_cmp_eq_u32 s45, 18
    s_cselect_b32 s45, 0, s45
    s_add_u32 s56, s56, 1
    s_cmp_eq_u32 s56, 18
    s_cselect_b32 s30, 1024, 0
    s_sub_u32 s41, s41, s30
    s_add_u32 m0, s51, 131072
    s_nop 0
    buffer_load_dwordx4 v4, s[16:19], s43 offen offset:0  lds
    v_mfma_f32_32x32x16_bf16 v[128:143], v[184:187], v[196:199], v[128:143]
    ds_read_b64_tr_b16 v[172:173], v20 offset:0
    ds_read_b64_tr_b16 v[174:175], v20 offset:4096
    buffer_load_dwordx4 v5, s[16:19], s43 offen offset:1024  lds
    v_mfma_f32_32x32x16_bf16 v[144:159], v[188:191], v[196:199], v[144:159]
    buffer_load_dwordx4 v6, s[16:19], s43 offen offset:2048  lds
    s_waitcnt lgkmcnt(6)
    v_mfma_f32_32x32x16_bf16 v[96:111], v[160:163], v[192:195], v[96:111]
    ds_read_b128 v[196:199], v16 offset:8192
    ds_read_b64_tr_b16 v[176:177], v17 offset:16384
    ds_read_b64_tr_b16 v[178:179], v17 offset:20480
    s_waitcnt lgkmcnt(7)
    v_mfma_f32_32x32x16_bf16 v[112:127], v[164:167], v[192:195], v[112:127]
    ds_read_b64_tr_b16 v[180:181], v18 offset:16384
    ds_read_b64_tr_b16 v[182:183], v18 offset:20480
    ds_read_b64_tr_b16 v[184:185], v19 offset:16384
    ds_read_b64_tr_b16 v[186:187], v19 offset:20480
    buffer_load_dwordx4 v7, s[16:19], s43 offen offset:3072  lds
    s_waitcnt lgkmcnt(9)
    v_mfma_f32_32x32x16_bf16 v[128:143], v[168:171], v[192:195], v[128:143]
    ds_read_b64_tr_b16 v[188:189], v20 offset:16384
    ds_read_b64_tr_b16 v[190:191], v20 offset:20480
    s_waitcnt lgkmcnt(9)
    v_mfma_f32_32x32x16_bf16 v[144:159], v[172:175], v[192:195], v[144:159]
    s_waitcnt vmcnt(4) lgkmcnt(0)
    s_barrier
    v_mfma_f32_32x32x16_bf16 v[96:111], v[176:179], v[196:199], v[96:111]
    ds_read_b128 v[192:195], v13 offset:32768
    ds_read_b64_tr_b16 v[160:161], v8 offset:16384
    ds_read_b64_tr_b16 v[162:163], v8 offset:20480
    v_mfma_f32_32x32x16_bf16 v[112:127], v[180:183], v[196:199], v[112:127]
    ds_read_b64_tr_b16 v[164:165], v9 offset:16384
    ds_read_b64_tr_b16 v[166:167], v9 offset:20480
    ds_read_b64_tr_b16 v[168:169], v10 offset:16384
    ds_read_b64_tr_b16 v[170:171], v10 offset:20480
    v_mfma_f32_32x32x16_bf16 v[128:143], v[184:187], v[196:199], v[128:143]
    ds_read_b64_tr_b16 v[172:173], v11 offset:16384
    ds_read_b64_tr_b16 v[174:175], v11 offset:20480
    v_mfma_f32_32x32x16_bf16 v[144:159], v[188:191], v[196:199], v[144:159]
    s_waitcnt lgkmcnt(6)
    v_mfma_f32_32x32x16_bf16 v[96:111], v[160:163], v[192:195], v[96:111]
    ds_read_b128 v[196:199], v14 offset:32768
    ds_read_b64_tr_b16 v[176:177], v8 offset:32768
    ds_read_b64_tr_b16 v[178:179], v8 offset:36864
    s_waitcnt lgkmcnt(7)
    v_mfma_f32_32x32x16_bf16 v[112:127], v[164:167], v[192:195], v[112:127]
    ds_read_b64_tr_b16 v[180:181], v9 offset:32768
    ds_read_b64_tr_b16 v[182:183], v9 offset:36864
    ds_read_b64_tr_b16 v[184:185], v10 offset:32768
    ds_read_b64_tr_b16 v[186:187], v10 offset:36864
    s_waitcnt lgkmcnt(9)
    v_mfma_f32_32x32x16_bf16 v[128:143], v[168:171], v[192:195], v[128:143]
    ds_read_b64_tr_b16 v[188:189], v11 offset:32768
    ds_read_b64_tr_b16 v[190:191], v11 offset:36864
    s_waitcnt lgkmcnt(9)
    v_mfma_f32_32x32x16_bf16 v[144:159], v[172:175], v[192:195], v[144:159]
    s_waitcnt vmcnt(0) lgkmcnt(0)
    s_barrier
    v_mfma_f32_32x32x16_bf16 v[96:111], v[176:179], v[196:199], v[96:111]
    ds_read_b128 v[192:195], v15 offset:32768
    ds_read_b64_tr_b16 v[160:161], v17 offset:32768
    ds_read_b64_tr_b16 v[162:163], v17 offset:36864
    v_mfma_f32_32x32x16_bf16 v[112:127], v[180:183], v[196:199], v[112:127]
    ds_read_b64_tr_b16 v[164:165], v18 offset:32768
    ds_read_b64_tr_b16 v[166:167], v18 offset:36864
    ds_read_b64_tr_b16 v[168:169], v19 offset:32768
    ds_read_b64_tr_b16 v[170:171], v19 offset:36864
    v_mfma_f32_32x32x16_bf16 v[128:143], v[184:187], v[196:199], v[128:143]
    ds_read_b64_tr_b16 v[172:173], v20 offset:32768
    ds_read_b64_tr_b16 v[174:175], v20 offset:36864
    v_mfma_f32_32x32x16_bf16 v[144:159], v[188:191], v[196:199], v[144:159]
    s_mul_i32 s30, s47, 1179648
    s_lshl_b32 s31, s48, 3
    s_add_u32 s31, s31, s28
    s_mul_i32 s31, s31, 4608
    s_add_u32 s30, s30, s31
    v_min_u32 v21, 35, v1
    v_lshlrev_b32 v21, 7, v21
    buffer_load_dword v3, v21, s[20:23], s30 offen
    s_cmp_eq_u32 s64, 0
    s_cbranch_scc1 LF_Q_nopre
    s_add_u32 m0, s40, 0
    s_nop 0
    buffer_load_dwordx4 v27, s[8:11], s38 offen offset:0 nt lds
    buffer_load_dwordx4 v28, s[8:11], s38 offen offset:1024 nt lds
    buffer_load_dwordx4 v29, s[8:11], s38 offen offset:2048 nt lds
    buffer_load_dwordx4 v30, s[8:11], s38 offen offset:3072 nt lds
    s_add_u32 s37, s37, 1
    s_add_u32 s30, s37, s66
    s_and_b32 s30, s30, 7
    s_lshl_b32 s30, s30, 14
    s_lshr_b32 s31, s37, 3
    s_lshl_b32 s31, s31, 18
    s_add_u32 s30, s30, s31
    s_add_u32 s38, s30, s39
    s_cmp_ge_u32 s37, 16
    s_cselect_b32 s38, 0x7f000000, s38
LF_Q_nopre:
    s_waitcnt lgkmcnt(6)
    v_mfma_f32_32x32x16_bf16 v[96:111], v[160:163], v[192:195], v[96:111]
    ds_read_b128 v[196:199], v16 offset:32768
    ds_read_b64_tr_b16 v[176:177], v17 offset:49152
    ds_read_b64_tr_b16 v[178:179], v17 offset:53248
    s_waitcnt lgkmcnt(7)
    v_mfma_f32_32x32x16_bf16 v[112:127], v[164:167], v[192:195], v[112:127]
    ds_read_b64_tr_b16 v[180:181], v18 offset:49152
    ds_read_b64_tr_b16 v[182:183], v18 offset:53248
    ds_read_b64_tr_b16 v[184:185], v19 offset:49152
    ds_read_b64_tr_b16 v[186:187], v19 offset:53248
    s_waitcnt lgkmcnt(9)
    v_mfma_f32_32x32x16_bf16 v[128:143], v[168:171], v[192:195], v[128:143]
    ds_read_b64_tr_b16 v[188:189], v20 offset:49152
    ds_read_b64_tr_b16 v[190:191], v20 offset:53248
    s_waitcnt lgkmcnt(9)
    v_mfma_f32_32x32x16_bf16 v[144:159], v[172:175], v[192:195], v[144:159]
    s_waitcnt lgkmcnt(6)
    v_mfma_f32_32x32x16_bf16 v[96:111], v[176:179], v[196:199], v[96:111]
    s_waitcnt lgkmcnt(4)
    v_mfma_f32_32x32x16_bf16 v[112:127], v[180:183], v[196:199], v[112:127]
    s_waitcnt lgkmcnt(2)
    v_mfma_f32_32x32x16_bf16 v[128:143], v[184:187], v[196:199], v[128:143]
    s_waitcnt lgkmcnt(0)
    v_mfma_f32_32x32x16_bf16 v[144:159], v[188:191], v[196:199], v[144:159]
    s_nop 5
    v_mul_f32 v96, s33, v96
    v_mul_f32 v97, s33, v97
    v_mul_f32 v98, s33, v98
    v_mul_f32 v99, s33, v99
    v_mul_f32 v100, s33, v100
    v_mul_f32 v101, s33, v101
    v_mul_f32 v102, s33, v102
    v_mul_f32 v103, s33, v103
    v_mul_f32 v104, s33, v104
    v_mul_f32 v105, s33, v105
    v_mul_f32 v106, s33, v106
    v_mul_f32 v107, s33, v107
    v_mul_f32 v108, s33, v108
    v_mul_f32 v109, s33, v109
    v_mul_f32 v110, s33, v110
    v_mul_f32 v111, s33, v111
    v_mul_f32 v112, s33, v112
    v_mul_f32 v113, s33, v113
    v_mul_f32 v114, s33, v114
    v_mul_f32 v115, s33, v115
    v_mul_f32 v116, s33, v116
    v_mul_f32 v117, s33, v117
    v_mul_f32 v118, s33, v118
    v_mul_f32 v119, s33, v119
    v_mul_f32 v120, s33, v120
    v_mul_f32 v121, s33, v121
    v_mul_f32 v122, s33, v122
    v_mul_f32 v123, s33, v123
    v_mul_f32 v124, s33, v124
    v_mul_f32 v125, s33, v125
    v_mul_f32 v126, s33, v126
    v_mul_f32 v127, s33, v127
    v_mul_f32 v128, s33, v128
    v_mul_f32 v129, s33, v129
    v_mul_f32 v130, s33, v130
    v_mul_f32 v131, s33, v131
    v_mul_f32 v132, s33, v132
    v_mul_f32 v133, s33, v133
    v_mul_f32 v134, s33, v134
    v_mul_f32 v135, s33, v135
    v_mul_f32 v136, s33, v136
    v_mul_f32 v137, s33, v137
    v_mul_f32 v138, s33, v138
    v_mul_f32 v139, s33, v139
    v_mul_f32 v140, s33, v140
    v_mul_f32 v141, s33, v141
    v_mul_f32 v142, s33, v142
    v_mul_f32 v143, s33, v143
    v_mul_f32 v144, s33, v144
    v_mul_f32 v145, s33, v145
    v_mul_f32 v146, s33, v146
    v_mul_f32 v147, s33, v147
    v_mul_f32 v148, s33, v148
    v_mul_f32 v149, s33, v149
    v_mul_f32 v150, s33, v150
    v_mul_f32 v151, s33, v151
    v_mul_f32 v152, s33, v152
    v_mul_f32 v153, s33, v153
    v_mul_f32 v154, s33, v154
    v_mul_f32 v155, s33, v155
    v_mul_f32 v156, s33, v156
    v_mul_f32 v157, s33, v157
    v_mul_f32 v158, s33, v158
    v_mul_f32 v159, s33, v159
    v_cvt_pk_bf16_f32 v32, v96, v97
    v_cvt_pk_bf16_f32 v33, v98, v99
    v_cvt_pk_bf16_f32 v34, v100, v101
    v_cvt_pk_bf16_f32 v35, v102, v103
    v_cvt_pk_bf16_f32 v36, v104, v105
    v_cvt_pk_bf16_f32 v37, v106, v107
    v_cvt_pk_bf16_f32 v38, v108, v109
    v_cvt_pk_bf16_f32 v39, v110, v111
    v_cvt_pk_bf16_f32 v40, v112, v113
    v_cvt_pk_bf16_f32 v41, v114, v115
    v_cvt_pk_bf16_f32 v42, v116, v117
    v_cvt_pk_bf16_f32 v43, v118, v119
    v_cvt_pk_bf16_f32 v44, v120, v121
    v_cvt_pk_bf16_f32 v45, v122, v123
    v_cvt_pk_bf16_f32 v46, v124, v125
    v_cvt_pk_bf16_f32 v47, v126, v127
    v_cvt_pk_bf16_f32 v48, v128, v129
    v_cvt_pk_bf16_f32 v49, v130, v131
    v_cvt_pk_bf16_f32 v50, v132, v133
    v_cvt_pk_bf16_f32 v51, v134, v135
    v_cvt_pk_bf16_f32 v52, v136, v137
    v_cvt_pk_bf16_f32 v53, v138, v139
    v_cvt_pk_bf16_f32 v54, v140, v141
    v_cvt_pk_bf16_f32 v55, v142, v143
    v_cvt_pk_bf16_f32 v56, v144, v145
    v_cvt_pk_bf16_f32 v57, v146, v147
    v_cvt_pk_bf16_f32 v58, v148, v149
    v_cvt_pk_bf16_f32 v59, v150, v151
    v_cvt_pk_bf16_f32 v60, v152, v153
    v_cvt_pk_bf16_f32 v61, v154, v155
    v_cvt_pk_bf16_f32 v62, v156, v157
    v_cvt_pk_bf16_f32 v63, v158, v159
    s_nop 7
    s_nop 7
    s_setpc_b64 s[58:59]
LF_S:
    s_barrier
    s_cmp_eq_u32 s64, 3
    s_cbranch_scc1 LF_S_pre3
    s_add_u32 m0, s40, 16384
    s_nop 0
    buffer_load_dwordx4 v31, s[12:15], s57 offen offset:0 nt lds
    buffer_load_dwordx4 v31, s[12:15], s57 offen offset:1024 nt lds
    buffer_load_dwordx4 v31, s[12:15], s57 offen offset:2048 nt lds
    buffer_load_dwordx4 v31, s[12:15], s57 offen offset:3072 nt lds
    s_add_u32 s63, s63, 1
    s_add_u32 s30, s63, s66
    s_and_b32 s30, s30, 7
    s_lshl_b32 s30, s30, 14
    s_lshr_b32 s31, s63, 3
    s_lshl_b32 s31, s31, 18
    s_add_u32 s30, s30, s31
    s_add_u32 s57, s30, s39
    s_cmp_ge_u32 s63, 16
    s_cselect_b32 s57, 0x7f000000, s57
    s_add_u32 m0, s40, 32768
    s_nop 0
    buffer_load_dwordx4 v27, s[8:11], s38 offen offset:0 nt lds
    buffer_load_dwordx4 v28, s[8:11], s38 offen offset:1024 nt lds
    buffer_load_dwordx4 v29, s[8:11], s38 offen offset:2048 nt lds
    buffer_load_dwordx4 v30, s[8:11], s38 offen offset:3072 nt lds
    s_add_u32 s37, s37, 1
    s_add_u32 s30, s37, s66
    s_and_b32 s30, s30, 7
    s_lshl_b32 s30, s30, 14
    s_lshr_b32 s31, s37, 3
    s_lshl_b32 s31, s31, 18
    s_add_u32 s30, s30, s31
    s_add_u32 s38, s30, s39
    s_cmp_ge_u32 s37, 16
    s_cselect_b32 s38, 0x7f000000, s38
LF_S_pre3:
    s_lshl_b32 s30, s29, 16
    v_and_b32 v18, 31, v1
    v_lshrrev_b32 v19, 5, v1
    v_and_b32 v20, 15, v1
    v_xor_b32 v20, v20, v19
    v_lshlrev_b32 v18, 8, v18
    v_add_u32 v18, s30, v18
    v_xor_b32 v21, 0, v20
    v_lshl_add_u32 v4, v21, 4, v18
    v_xor_b32 v21, 2, v20
    v_lshl_add_u32 v5, v21, 4, v18
    v_xor_b32 v21, 4, v20
    v_lshl_add_u32 v6, v21, 4, v18
    v_xor_b32 v21, 6, v20
    v_lshl_add_u32 v7, v21, 4, v18
    v_xor_b32 v21, 8, v20
    v_lshl_add_u32 v8, v21, 4, v18
    v_xor_b32 v21, 10, v20
    v_lshl_add_u32 v9, v21, 4, v18
    v_xor_b32 v21, 12, v20
    v_lshl_add_u32 v10, v21, 4, v18
    v_xor_b32 v21, 14, v20
    v_lshl_add_u32 v11, v21, 4, v18
    v_bfe_u32 v18, v1, 2, 2
    v_and_b32 v20, 3, v1
    v_bfe_u32 v21, v1, 4, 1
    v_lshl_add_u32 v22, v19, 2, v18
    v_lshlrev_b32 v22, 8, v22
    v_lshl_add_u32 v22, v21, 5, v22
    v_lshl_add_u32 v22, v20, 3, v22
    v_add_u32 v22, s30, v22
    v_xor_b32 v23, 0, v18
    v_lshl_add_u32 v12, v23, 6, v22
    v_xor_b32 v23, 1, v18
    v_lshl_add_u32 v13, v23, 6, v22
    v_xor_b32 v23, 2, v18
    v_lshl_add_u32 v14, v23, 6, v22
    v_xor_b32 v23, 3, v18
    v_lshl_add_u32 v15, v23, 6, v22
    v_mov_b32 v96, 0
    v_mov_b32 v97, 0
    v_mov_b32 v98, 0
    v_mov_b32 v99, 0
    v_mov_b32 v100, 0
    v_mov_b32 v101, 0
    v_mov_b32 v102, 0
    v_mov_b32 v103, 0
    v_mov_b32 v104, 0
    v_mov_b32 v105, 0
    v_mov_b32 v106, 0
    v_mov_b32 v107, 0
    v_mov_b32 v108, 0
    v_mov_b32 v109, 0
    v_mov_b32 v110, 0
    v_mov_b32 v111, 0
    v_mov_b32 v112, 0
    v_mov_b32 v113, 0
    v_mov_b32 v114, 0
    v_mov_b32 v115, 0
    v_mov_b32 v116, 0
    v_mov_b32 v117, 0
    v_mov_b32 v118, 0
    v_mov_b32 v119, 0
    v_mov_b32 v120, 0
    v_mov_b32 v121, 0
    v_mov_b32 v122, 0
    v_mov_b32 v123, 0
    v_mov_b32 v124, 0
    v_mov_b32 v125, 0
    v_mov_b32 v126, 0
    v_mov_b32 v127, 0
    v_mov_b32 v128, 0
    v_mov_b32 v129, 0
    v_mov_b32 v130, 0
    v_mov_b32 v131, 0
    v_mov_b32 v132, 0
    v_mov_b32 v133, 0
    v_mov_b32 v134, 0
    v_mov_b32 v135, 0
    v_mov_b32 v136, 0
    v_mov_b32 v137, 0
    v_mov_b32 v138, 0
    v_mov_b32 v139, 0
    v_mov_b32 v140, 0
    v_mov_b32 v141, 0
    v_mov_b32 v142, 0
    v_mov_b32 v143, 0
    v_mov_b32 v144, 0
    v_mov_b32 v145, 0
    v_mov_b32 v146, 0
    v_mov_b32 v147, 0
    v_mov_b32 v148, 0
    v_mov_b32 v149, 0
    v_mov_b32 v150, 0
    v_mov_b32 v151, 0
    v_mov_b32 v152, 0
    v_mov_b32 v153, 0
    v_mov_b32 v154, 0
    v_mov_b32 v155, 0
    v_mov_b32 v156, 0
    v_mov_b32 v157, 0
    v_mov_b32 v158, 0
    v_mov_b32 v159, 0
    v_mov_b32 v192, 0
    v_mov_b32 v193, 0
    v_mov_b32 v194, 0
    v_mov_b32 v195, 0
    v_mov_b32 v196, 0
    v_mov_b32 v197, 0
    v_mov_b32 v198, 0
    v_mov_b32 v199, 0
    v_mov_b32 v200, 0
    v_mov_b32 v201, 0
    v_mov_b32 v202, 0
    v_mov_b32 v203, 0
    v_mov_b32 v204, 0
    v_mov_b32 v205, 0
    v_mov_b32 v206, 0
    v_mov_b32 v207, 0
    v_mov_b32 v17, 0
    v_mov_b32 v16, 0
    s_mov_b32 s34, 0xff800000
    s_mov_b32 s67, 0xff800000
    s_mov_b32 s36, 0
    s_waitcnt vmcnt(8)
    s_barrier
    s_cmp_eq_u32 s29, 0
    s_cbranch_scc1 LF_S_nst
    s_barrier
LF_S_nst:
    ds_read_b128 v[208:211], v4 offset:0
    ds_read_b128 v[212:215], v5 offset:0
    ds_read_b128 v[216:219], v6 offset:0
    ds_read_b128 v[220:223], v7 offset:0
LF_Sloop0:
    ds_read_b128 v[224:227], v8 offset:0
    ds_read_b128 v[228:231], v9 offset:0
    s_waitcnt lgkmcnt(4)
    v_mfma_f32_32x32x16_bf16 v[160:175], v[208:211], v[32:35], v[192:207]
    ds_read_b128 v[232:235], v10 offset:0
    v_mfma_f32_32x32x16_bf16 v[160:175], v[212:215], v[36:39], v[160:175]
    ds_read_b128 v[236:239], v11 offset:0
    s_add_u32 m0, s40, 49152
    s_nop 0
    buffer_load_dwordx4 v31, s[12:15], s57 offen offset:0 nt lds
    s_waitcnt lgkmcnt(4)
    v_mfma_f32_32x32x16_bf16 v[160:175], v[216:219], v[40:43], v[160:175]
    ds_read_b128 v[208:211], v4 offset:8192
    v_mfma_f32_32x32x16_bf16 v[160:175], v[220:223], v[44:47], v[160:175]
    ds_read_b128 v[212:215], v5 offset:8192
    buffer_load_dwordx4 v31, s[12:15], s57 offen offset:1024 nt lds
    s_waitcnt lgkmcnt(4)
    v_mfma_f32_32x32x16_bf16 v[160:175], v[224:227], v[48:51], v[160:175]
    ds_read_b128 v[216:219], v6 offset:8192
    v_mfma_f32_32x32x16_bf16 v[160:175], v[228:231], v[52:55], v[160:175]
    ds_read_b128 v[220:223], v7 offset:8192
    buffer_load_dwordx4 v31, s[12:15], s57 offen offset:2048 nt lds
    s_waitcnt lgkmcnt(4)
    v_mfma_f32_32x32x16_bf16 v[160:175], v[232:235], v[56:59], v[160:175]
    ds_read_b128 v[224:227], v8 offset:8192
    v_mfma_f32_32x32x16_bf16 v[160:175], v[236:239], v[60:63], v[160:175]
    ds_read_b128 v[228:231], v9 offset:8192
    buffer_load_dwordx4 v31, s[12:15], s57 offen offset:3072 nt lds
    s_add_u32 s63, s63, 1
    s_add_u32 s30, s63, s66
    s_and_b32 s30, s30, 7
    s_lshl_b32 s30, s30, 14
    s_lshr_b32 s31, s63, 3
    s_lshl_b32 s31, s31, 18
    s_add_u32 s30, s30, s31
    s_add_u32 s57, s30, s39
    s_cmp_ge_u32 s63, 16
    s_cselect_b32 s57, 0x7f000000, s57
    s_waitcnt lgkmcnt(4)
    v_mfma_f32_32x32x16_bf16 v[176:191], v[208:211], v[32:35], v[192:207]
    ds_read_b128 v[232:235], v10 offset:8192
    v_mfma_f32_32x32x16_bf16 v[176:191], v[212:215], v[36:39], v[176:191]
    ds_read_b128 v[236:239], v11 offset:8192
    s_waitcnt lgkmcnt(4)
    v_mfma_f32_32x32x16_bf16 v[176:191], v[216:219], v[40:43], v[176:191]
    v_mfma_f32_32x32x16_bf16 v[176:191], v[220:223], v[44:47], v[176:191]
    v_max3_f32 v18, v160, v161, v162
    v_max3_f32 v18, v18, v163, v164
    s_waitcnt lgkmcnt(2)
    s_waitcnt lgkmcnt(0)
    s_waitcnt vmcnt(8)
    s_barrier
    v_mfma_f32_32x32x16_bf16 v[176:191], v[224:227], v[48:51], v[176:191]
    ds_read_b64_tr_b16 v[240:241], v12 offset:16384
    ds_read_b64_tr_b16 v[242:243], v12 offset:18432
    v_max3_f32 v18, v18, v165, v166
    v_max3_f32 v18, v18, v167, v168
    v_mfma_f32_32x32x16_bf16 v[176:191], v[228:231], v[52:55], v[176:191]
    ds_read_b64_tr_b16 v[244:245], v13 offset:16384
    ds_read_b64_tr_b16 v[246:247], v13 offset:18432
    v_max3_f32 v18, v18, v169, v170
    v_max3_f32 v18, v18, v171, v172
    v_mfma_f32_32x32x16_bf16 v[176:191], v[232:235], v[56:59], v[176:191]
    ds_read_b64_tr_b16 v[248:249], v14 offset:16384
    ds_read_b64_tr_b16 v[250:251], v14 offset:18432
    s_add_u32 m0, s40, 0
    s_nop 0
    buffer_load_dwordx4 v27, s[8:11], s38 offen offset:0 nt lds
    v_max3_f32 v18, v18, v173, v174
    v_max_f32 v18, v18, v175
    v_mfma_f32_32x32x16_bf16 v[176:191], v[236:239], v[60:63], v[176:191]
    ds_read_b64_tr_b16 v[252:253], v15 offset:16384
    ds_read_b64_tr_b16 v[254:255], v15 offset:18432
    ds_read_b64_tr_b16 v[208:209], v12 offset:20480
    ds_read_b64_tr_b16 v[210:211], v12 offset:22528
    ds_read_b64_tr_b16 v[212:213], v13 offset:20480
    ds_read_b64_tr_b16 v[214:215], v13 offset:22528
    ds_read_b64_tr_b16 v[216:217], v14 offset:20480
    ds_read_b64_tr_b16 v[218:219], v14 offset:22528
    s_nop 3
    v_max3_f32 v18, v18, v176, v177
    v_max3_f32 v18, v18, v178, v179
    v_max3_f32 v18, v18, v180, v181
    v_max3_f32 v18, v18, v182, v183
    v_max3_f32 v18, v18, v184, v185
    v_max3_f32 v18, v18, v186, v187
    v_max3_f32 v18, v18, v188, v189
    v_max3_f32 v18, v18, v190, v191
    v_mov_b32 v19, v18
    s_nop 1
    v_permlane32_swap_b32 v18, v19
    v_max_f32 v18, v18, v19
    v_cmp_lt_f32 vcc, s34, v18
    s_cbranch_vccnz LF_rare00
LF_back00:
    v_exp_f32 v160, v160
    v_exp_f32 v161, v161
    v_exp_f32 v162, v162
    v_exp_f32 v163, v163
    v_exp_f32 v164, v164
    v_exp_f32 v165, v165
    v_exp_f32 v166, v166
    v_exp_f32 v167, v167
    v_add_f32 v17, v17, v160
    v_add_f32 v16, v16, v161
    v_add_f32 v17, v17, v162
    v_add_f32 v16, v16, v163
    v_add_f32 v17, v17, v164
    v_add_f32 v16, v16, v165
    v_add_f32 v17, v17, v166
    v_add_f32 v16, v16, v167
    v_cvt_pk_bf16_f32 v160, v160, v161
    v_cvt_pk_bf16_f32 v161, v162, v163
    v_cvt_pk_bf16_f32 v162, v164, v165
    v_cvt_pk_bf16_f32 v163, v166, v167
    s_waitcnt lgkmcnt(10)
    s_nop 0
    v_mfma_f32_32x32x16_bf16 v[96:111], v[240:243], v[160:163], v[96:111]
    ds_read_b64_tr_b16 v[220:221], v15 offset:20480
    ds_read_b64_tr_b16 v[222:223], v15 offset:22528
    ds_read_b64_tr_b16 v[224:225], v12 offset:24576
    ds_read_b64_tr_b16 v[226:227], v12 offset:26624
    v_exp_f32 v168, v168
    v_exp_f32 v169, v169
    v_exp_f32 v170, v170
    v_exp_f32 v171, v171
    v_exp_f32 v172, v172
    v_mfma_f32_32x32x16_bf16 v[112:127], v[244:247], v[160:163], v[112:127]
    s_waitcnt lgkmcnt(12)
    ds_read_b64_tr_b16 v[228:229], v13 offset:24576
    ds_read_b64_tr_b16 v[230:231], v13 offset:26624
    s_waitcnt lgkmcnt(12)
    ds_read_b64_tr_b16 v[232:233], v14 offset:24576
    ds_read_b64_tr_b16 v[234:235], v14 offset:26624
    buffer_load_dwordx4 v28, s[8:11], s38 offen offset:1024 nt lds
    v_exp_f32 v173, v173
    v_exp_f32 v174, v174
    v_exp_f32 v175, v175
    v_add_f32 v17, v17, v168
    v_add_f32 v16, v16, v169
    v_mfma_f32_32x32x16_bf16 v[128:143], v[248:251], v[160:163], v[128:143]
    s_waitcnt lgkmcnt(12)
    ds_read_b64_tr_b16 v[236:237], v15 offset:24576
    ds_read_b64_tr_b16 v[238:239], v15 offset:26624
    s_waitcnt lgkmcnt(12)
    ds_read_b64_tr_b16 v[240:241], v12 offset:28672
    ds_read_b64_tr_b16 v[242:243], v12 offset:30720
    v_add_f32 v17, v17, v170
    v_add_f32 v16, v16, v171
    v_add_f32 v17, v17, v172
    v_add_f32 v16, v16, v173
    v_add_f32 v17, v17, v174
    v_mfma_f32_32x32x16_bf16 v[144:159], v[252:255], v[160:163], v[144:159]
    s_waitcnt lgkmcnt(12)
    ds_read_b64_tr_b16 v[244:245], v13 offset:28672
    ds_read_b64_tr_b16 v[246:247], v13 offset:30720
    s_waitcnt lgkmcnt(12)
    ds_read_b64_tr_b16 v[248:249], v14 offset:28672
    ds_read_b64_tr_b16 v[250:251], v14 offset:30720
    v_add_f32 v16, v16, v175
    v_cvt_pk_bf16_f32 v168, v168, v169
    v_cvt_pk_bf16_f32 v169, v170, v171
    v_cvt_pk_bf16_f32 v170, v172, v173
    v_cvt_pk_bf16_f32 v171, v174, v175
    s_nop 1
    v_mfma_f32_32x32x16_bf16 v[96:111], v[208:211], v[168:171], v[96:111]
    s_waitcnt lgkmcnt(12)
    ds_read_b64_tr_b16 v[252:253], v15 offset:28672
    ds_read_b64_tr_b16 v[254:255], v15 offset:30720
    buffer_load_dwordx4 v29, s[8:11], s38 offen offset:2048 nt lds
    v_exp_f32 v176, v176
    v_exp_f32 v177, v177
    v_exp_f32 v178, v178
    v_exp_f32 v179, v179
    v_exp_f32 v180, v180
    v_mfma_f32_32x32x16_bf16 v[112:127], v[212:215], v[168:171], v[112:127]
    v_exp_f32 v181, v181
    v_exp_f32 v182, v182
    v_exp_f32 v183, v183
    v_add_f32 v17, v17, v176
    v_add_f32 v16, v16, v177
    v_mfma_f32_32x32x16_bf16 v[128:143], v[216:219], v[168:171], v[128:143]
    buffer_load_dwordx4 v30, s[8:11], s38 offen offset:3072 nt lds
    s_add_u32 s37, s37, 1
    s_add_u32 s30, s37, s66
    s_and_b32 s30, s30, 7
    s_lshl_b32 s30, s30, 14
    s_lshr_b32 s31, s37, 3
    s_lshl_b32 s31, s31, 18
    s_add_u32 s30, s30, s31
    s_add_u32 s38, s30, s39
    s_cmp_ge_u32 s37, 16
    s_cselect_b32 s38, 0x7f000000, s38
    v_add_f32 v17, v17, v178
    v_add_f32 v16, v16, v179
    v_add_f32 v17, v17, v180
    v_add_f32 v16, v16, v181
    v_add_f32 v17, v17, v182
    v_mfma_f32_32x32x16_bf16 v[144:159], v[220:223], v[168:171], v[144:159]
    v_add_f32 v16, v16, v183
    v_cvt_pk_bf16_f32 v176, v176, v177
    v_cvt_pk_bf16_f32 v177, v178, v179
    v_cvt_pk_bf16_f32 v178, v180, v181
    v_cvt_pk_bf16_f32 v179, v182, v183
    s_waitcnt lgkmcnt(0)
    s_waitcnt vmcnt(8)
    s_barrier
    v_mfma_f32_32x32x16_bf16 v[96:111], v[224:227], v[176:179], v[96:111]
    v_exp_f32 v184, v184
    v_exp_f32 v185, v185
    v_exp_f32 v186, v186
    v_exp_f32 v187, v187
    v_exp_f32 v188, v188
    v_mfma_f32_32x32x16_bf16 v[112:127], v[228:231], v[176:179], v[112:127]
    v_exp_f32 v189, v189
    v_exp_f32 v190, v190
    v_exp_f32 v191, v191
    v_add_f32 v17, v17, v184
    v_add_f32 v16, v16, v185
    v_mfma_f32_32x32x16_bf16 v[128:143], v[232:235], v[176:179], v[128:143]
    v_add_f32 v17, v17, v186
    v_add_f32 v16, v16, v187
    v_add_f32 v17, v17, v188
    v_add_f32 v16, v16, v189
    v_add_f32 v17, v17, v190
    v_mfma_f32_32x32x16_bf16 v[144:159], v[236:239], v[176:179], v[144:159]
    v_add_f32 v16, v16, v191
    v_cvt_pk_bf16_f32 v184, v184, v185
    v_cvt_pk_bf16_f32 v185, v186, v187
    v_cvt_pk_bf16_f32 v186, v188, v189
    v_cvt_pk_bf16_f32 v187, v190, v191
    s_nop 1
    v_mfma_f32_32x32x16_bf16 v[96:111], v[240:243], v[184:187], v[96:111]
    ds_read_b128 v[208:211], v4 offset:32768
    v_mfma_f32_32x32x16_bf16 v[112:127], v[244:247], v[184:187], v[112:127]
    ds_read_b128 v[212:215], v5 offset:32768
    v_mfma_f32_32x32x16_bf16 v[128:143], v[248:251], v[184:187], v[128:143]
    ds_read_b128 v[216:219], v6 offset:32768
    v_mfma_f32_32x32x16_bf16 v[144:159], v[252:255], v[184:187], v[144:159]
    ds_read_b128 v[220:223], v7 offset:32768
    ds_read_b128 v[224:227], v8 offset:32768
    ds_read_b128 v[228:231], v9 offset:32768
    s_waitcnt lgkmcnt(4)
    v_mfma_f32_32x32x16_bf16 v[160:175], v[208:211], v[32:35], v[192:207]
    ds_read_b128 v[232:235], v10 offset:32768
    v_mfma_f32_32x32x16_bf16 v[160:175], v[212:215], v[36:39], v[160:175]
    ds_read_b128 v[236:239], v11 offset:32768
    s_add_u32 m0, s40, 16384
    s_nop 0
    buffer_load_dwordx4 v31, s[12:15], s57 offen offset:0 nt lds
    s_waitcnt lgkmcnt(4)
    v_mfma_f32_32x32x16_bf16 v[160:175], v[216:219], v[40:43], v[160:175]
    ds_read_b128 v[208:211], v4 offset:40960
    v_mfma_f32_32x32x16_bf16 v[160:175], v[220:223], v[44:47], v[160:175]
    ds_read_b128 v[212:215], v5 offset:40960
    buffer_load_dwordx4 v31, s[12:15], s57 offen offset:1024 nt lds
    s_waitcnt lgkmcnt(4)
    v_mfma_f32_32x32x16_bf16 v[160:175], v[224:227], v[48:51], v[160:175]
    ds_read_b128 v[216:219], v6 offset:40960
    v_mfma_f32_32x32x16_bf16 v[160:175], v[228:231], v[52:55], v[160:175]
    ds_read_b128 v[220:223], v7 offset:40960
    buffer_load_dwordx4 v31, s[12:15], s57 offen offset:2048 nt lds
    s_waitcnt lgkmcnt(4)
    v_mfma_f32_32x32x16_bf16 v[160:175], v[232:235], v[56:59], v[160:175]
    ds_read_b128 v[224:227], v8 offset:40960
    v_mfma_f32_32x32x16_bf16 v[160:175], v[236:239], v[60:63], v[160:175]
    ds_read_b128 v[228:231], v9 offset:40960
    buffer_load_dwordx4 v31, s[12:15], s57 offen offset:3072 nt lds
    s_add_u32 s63, s63, 1
    s_add_u32 s30, s63, s66
    s_and_b32 s30, s30, 7
    s_lshl_b32 s30, s30, 14
    s_lshr_b32 s31, s63, 3
    s_lshl_b32 s31, s31, 18
    s_add_u32 s30, s30, s31
    s_add_u32 s57, s30, s39
    s_cmp_ge_u32 s63, 16
    s_cselect_b32 s57, 0x7f000000, s57
    s_waitcnt lgkmcnt(4)
    v_mfma_f32_32x32x16_bf16 v[176:191], v[208:211], v[32:35], v[192:207]
    ds_read_b128 v[232:235], v10 offset:40960
    v_mfma_f32_32x32x16_bf16 v[176:191], v[212:215], v[36:39], v[176:191]
    ds_read_b128 v[236:239], v11 offset:40960
    s_waitcnt lgkmcnt(4)
    v_mfma_f32_32x32x16_bf16 v[176:191], v[216:219], v[40:43], v[176:191]
    v_mfma_f32_32x32x16_bf16 v[176:191], v[220:223], v[44:47], v[176:191]
    v_max3_f32 v18, v160, v161, v162
    v_max3_f32 v18, v18, v163, v164
    s_waitcnt lgkmcnt(2)
    s_waitcnt lgkmcnt(0)
    s_waitcnt vmcnt(8)
    s_barrier
    v_mfma_f32_32x32x16_bf16 v[176:191], v[224:227], v[48:51], v[176:191]
    ds_read_b64_tr_b16 v[240:241], v12 offset:49152
    ds_read_b64_tr_b16 v[242:243], v12 offset:51200
    v_max3_f32 v18, v18, v165, v166
    v_max3_f32 v18, v18, v167, v168
    v_mfma_f32_32x32x16_bf16 v[176:191], v[228:231], v[52:55], v[176:191]
    ds_read_b64_tr_b16 v[244:245], v13 offset:49152
    ds_read_b64_tr_b16 v[246:247], v13 offset:51200
    v_max3_f32 v18, v18, v169, v170
    v_max3_f32 v18, v18, v171, v172
    v_mfma_f32_32x32x16_bf16 v[176:191], v[232:235], v[56:59], v[176:191]
    ds_read_b64_tr_b16 v[248:249], v14 offset:49152
    ds_read_b64_tr_b16 v[250:251], v14 offset:51200
    s_add_u32 m0, s40, 32768
    s_nop 0
    buffer_load_dwordx4 v27, s[8:11], s38 offen offset:0 nt lds
    v_max3_f32 v18, v18, v173, v174
    v_max_f32 v18, v18, v175
    v_mfma_f32_32x32x16_bf16 v[176:191], v[236:239], v[60:63], v[176:191]
    ds_read_b64_tr_b16 v[252:253], v15 offset:49152
    ds_read_b64_tr_b16 v[254:255], v15 offset:51200
    ds_read_b64_tr_b16 v[208:209], v12 offset:53248
    ds_read_b64_tr_b16 v[210:211], v12 offset:55296
    ds_read_b64_tr_b16 v[212:213], v13 offset:53248
    ds_read_b64_tr_b16 v[214:215], v13 offset:55296
    ds_read_b64_tr_b16 v[216:217], v14 offset:53248
    ds_read_b64_tr_b16 v[218:219], v14 offset:55296
    s_nop 3
    v_max3_f32 v18, v18, v176, v177
    v_max3_f32 v18, v18, v178, v179
    v_max3_f32 v18, v18, v180, v181
    v_max3_f32 v18, v18, v182, v183
    v_max3_f32 v18, v18, v184, v185
    v_max3_f32 v18, v18, v186, v187
    v_max3_f32 v18, v18, v188, v189
    v_max3_f32 v18, v18, v190, v191
    v_mov_b32 v19, v18
    s_nop 1
    v_permlane32_swap_b32 v18, v19
    v_max_f32 v18, v18, v19
    v_cmp_lt_f32 vcc, s34, v18
    s_cbranch_vccnz LF_rare01
LF_back01:
    v_exp_f32 v160, v160
    v_exp_f32 v161, v161
    v_exp_f32 v162, v162
    v_exp_f32 v163, v163
    v_exp_f32 v164, v164
    v_exp_f32 v165, v165
    v_exp_f32 v166, v166
    v_exp_f32 v167, v167
    v_add_f32 v17, v17, v160
    v_add_f32 v16, v16, v161
    v_add_f32 v17, v17, v162
    v_add_f32 v16, v16, v163
    v_add_f32 v17, v17, v164
    v_add_f32 v16, v16, v165
    v_add_f32 v17, v17, v166
    v_add_f32 v16, v16, v167
    v_cvt_pk_bf16_f32 v160, v160, v161
    v_cvt_pk_bf16_f32 v161, v162, v163
    v_cvt_pk_bf16_f32 v162, v164, v165
    v_cvt_pk_bf16_f32 v163, v166, v167
    s_waitcnt lgkmcnt(10)
    s_nop 0
    v_mfma_f32_32x32x16_bf16 v[96:111], v[240:243], v[160:163], v[96:111]
    ds_read_b64_tr_b16 v[220:221], v15 offset:53248
    ds_read_b64_tr_b16 v[222:223], v15 offset:55296
    ds_read_b64_tr_b16 v[224:225], v12 offset:57344
    ds_read_b64_tr_b16 v[226:227], v12 offset:59392
    v_exp_f32 v168, v168
    v_exp_f32 v169, v169
    v_exp_f32 v170, v170
    v_exp_f32 v171, v171
    v_exp_f32 v172, v172
    v_mfma_f32_32x32x16_bf16 v[112:127], v[244:247], v[160:163], v[112:127]
    s_waitcnt lgkmcnt(12)
    ds_read_b64_tr_b16 v[228:229], v13 offset:57344
    ds_read_b64_tr_b16 v[230:231], v13 offset:59392
    s_waitcnt lgkmcnt(12)
    ds_read_b64_tr_b16 v[232:233], v14 offset:57344
    ds_read_b64_tr_b16 v[234:235], v14 offset:59392
    buffer_load_dwordx4 v28, s[8:11], s38 offen offset:1024 nt lds
    v_exp_f32 v173, v173
    v_exp_f32 v174, v174
    v_exp_f32 v175, v175
    v_add_f32 v17, v17, v168
    v_add_f32 v16, v16, v169
    v_mfma_f32_32x32x16_bf16 v[128:143], v[248:251], v[160:163], v[128:143]
    s_waitcnt lgkmcnt(12)
    ds_read_b64_tr_b16 v[236:237], v15 offset:57344
    ds_read_b64_tr_b16 v[238:239], v15 offset:59392
    s_waitcnt lgkmcnt(12)
    ds_read_b64_tr_b16 v[240:241], v12 offset:61440
    ds_read_b64_tr_b16 v[242:243], v12 offset:63488
    v_add_f32 v17, v17, v170
    v_add_f32 v16, v16, v171
    v_add_f32 v17, v17, v172
    v_add_f32 v16, v16, v173
    v_add_f32 v17, v17, v174
    v_mfma_f32_32x32x16_bf16 v[144:159], v[252:255], v[160:163], v[144:159]
    s_waitcnt lgkmcnt(12)
    ds_read_b64_tr_b16 v[244:245], v13 offset:61440
    ds_read_b64_tr_b16 v[246:247], v13 offset:63488
    s_waitcnt lgkmcnt(12)
    ds_read_b64_tr_b16 v[248:249], v14 offset:61440
    ds_read_b64_tr_b16 v[250:251], v14 offset:63488
    v_add_f32 v16, v16, v175
    v_cvt_pk_bf16_f32 v168, v168, v169
    v_cvt_pk_bf16_f32 v169, v170, v171
    v_cvt_pk_bf16_f32 v170, v172, v173
    v_cvt_pk_bf16_f32 v171, v174, v175
    s_nop 1
    v_mfma_f32_32x32x16_bf16 v[96:111], v[208:211], v[168:171], v[96:111]
    s_waitcnt lgkmcnt(12)
    ds_read_b64_tr_b16 v[252:253], v15 offset:61440
    ds_read_b64_tr_b16 v[254:255], v15 offset:63488
    buffer_load_dwordx4 v29, s[8:11], s38 offen offset:2048 nt lds
    v_exp_f32 v176, v176
    v_exp_f32 v177, v177
    v_exp_f32 v178, v178
    v_exp_f32 v179, v179
    v_exp_f32 v180, v180
    v_mfma_f32_32x32x16_bf16 v[112:127], v[212:215], v[168:171], v[112:127]
    v_exp_f32 v181, v181
    v_exp_f32 v182, v182
    v_exp_f32 v183, v183
    v_add_f32 v17, v17, v176
    v_add_f32 v16, v16, v177
    v_mfma_f32_32x32x16_bf16 v[128:143], v[216:219], v[168:171], v[128:143]
    buffer_load_dwordx4 v30, s[8:11], s38 offen offset:3072 nt lds
    s_add_u32 s37, s37, 1
    s_add_u32 s30, s37, s66
    s_and_b32 s30, s30, 7
    s_lshl_b32 s30, s30, 14
    s_lshr_b32 s31, s37, 3
    s_lshl_b32 s31, s31, 18
    s_add_u32 s30, s30, s31
    s_add_u32 s38, s30, s39
    s_cmp_ge_u32 s37, 16
    s_cselect_b32 s38, 0x7f000000, s38
    v_add_f32 v17, v17, v178
    v_add_f32 v16, v16, v179
    v_add_f32 v17, v17, v180
    v_add_f32 v16, v16, v181
    v_add_f32 v17, v17, v182
    v_mfma_f32_32x32x16_bf16 v[144:159], v[220:223], v[168:171], v[144:159]
    v_add_f32 v16, v16, v183
    v_cvt_pk_bf16_f32 v176, v176, v177
    v_cvt_pk_bf16_f32 v177, v178, v179
    v_cvt_pk_bf16_f32 v178, v180, v181
    v_cvt_pk_bf16_f32 v179, v182, v183
    s_waitcnt lgkmcnt(0)
    s_waitcnt vmcnt(8)
    s_barrier
    v_mfma_f32_32x32x16_bf16 v[96:111], v[224:227], v[176:179], v[96:111]
    v_exp_f32 v184, v184
    v_exp_f32 v185, v185
    v_exp_f32 v186, v186
    v_exp_f32 v187, v187
    v_exp_f32 v188, v188
    v_mfma_f32_32x32x16_bf16 v[112:127], v[228:231], v[176:179], v[112:127]
    v_exp_f32 v189, v189
    v_exp_f32 v190, v190
    v_exp_f32 v191, v191
    v_add_f32 v17, v17, v184
    v_add_f32 v16, v16, v185
    v_mfma_f32_32x32x16_bf16 v[128:143], v[232:235], v[176:179], v[128:143]
    v_add_f32 v17, v17, v186
    v_add_f32 v16, v16, v187
    v_add_f32 v17, v17, v188
    v_add_f32 v16, v16, v189
    v_add_f32 v17, v17, v190
    v_mfma_f32_32x32x16_bf16 v[144:159], v[236:239], v[176:179], v[144:159]
    v_add_f32 v16, v16, v191
    v_cvt_pk_bf16_f32 v184, v184, v185
    v_cvt_pk_bf16_f32 v185, v186, v187
    v_cvt_pk_bf16_f32 v186, v188, v189
    v_cvt_pk_bf16_f32 v187, v190, v191
    s_nop 1
    v_mfma_f32_32x32x16_bf16 v[96:111], v[240:243], v[184:187], v[96:111]
    ds_read_b128 v[208:211], v4 offset:0
    v_mfma_f32_32x32x16_bf16 v[112:127], v[244:247], v[184:187], v[112:127]
    ds_read_b128 v[212:215], v5 offset:0
    v_mfma_f32_32x32x16_bf16 v[128:143], v[248:251], v[184:187], v[128:143]
    ds_read_b128 v[216:219], v6 offset:0
    v_mfma_f32_32x32x16_bf16 v[144:159], v[252:255], v[184:187], v[144:159]
    ds_read_b128 v[220:223], v7 offset:0
    s_add_u32 s36, s36, 1
    s_cmp_lt_u32 s36, 4
    s_cbranch_scc1 LF_Sloop0
    s_cmp_lg_u32 s29, 0
    s_cbranch_scc1 LF_S_nst2
    s_barrier
LF_S_nst2:
    v_add_f32 v17, v17, v16
    v_mov_b32 v18, v17
    s_nop 1
    v_permlane32_swap_b32 v17, v18
    v_add_f32 v18, v18, v17
    v_rcp_f32 v19, v18
    s_nop 0
    v_mul_f32 v96, v96, v19
    v_mul_f32 v97, v97, v19
    v_mul_f32 v98, v98, v19
    v_mul_f32 v99, v99, v19
    v_mul_f32 v100, v100, v19
    v_mul_f32 v101, v101, v19
    v_mul_f32 v102, v102, v19
    v_mul_f32 v103, v103, v19
    v_mul_f32 v104, v104, v19
    v_mul_f32 v105, v105, v19
    v_mul_f32 v106, v106, v19
    v_mul_f32 v107, v107, v19
    v_mul_f32 v108, v108, v19
    v_mul_f32 v109, v109, v19
    v_mul_f32 v110, v110, v19
    v_mul_f32 v111, v111, v19
    v_cvt_pk_bf16_f32 v32, v96, v97
    v_cvt_pk_bf16_f32 v33, v98, v99
    v_cvt_pk_bf16_f32 v34, v104, v105
    v_cvt_pk_bf16_f32 v35, v106, v107
    v_cvt_pk_bf16_f32 v36, v100, v101
    v_cvt_pk_bf16_f32 v37, v102, v103
    v_cvt_pk_bf16_f32 v38, v108, v109
    v_cvt_pk_bf16_f32 v39, v110, v111
    v_mul_f32 v112, v112, v19
    v_mul_f32 v113, v113, v19
    v_mul_f32 v114, v114, v19
    v_mul_f32 v115, v115, v19
    v_mul_f32 v116, v116, v19
    v_mul_f32 v117, v117, v19
    v_mul_f32 v118, v118, v19
    v_mul_f32 v119, v119, v19
    v_mul_f32 v120, v120, v19
    v_mul_f32 v121, v121, v19
    v_mul_f32 v122, v122, v19
    v_mul_f32 v123, v123, v19
    v_mul_f32 v124, v124, v19
    v_mul_f32 v125, v125, v19
    v_mul_f32 v126, v126, v19
    v_mul_f32 v127, v127, v19
    v_cvt_pk_bf16_f32 v40, v112, v113
    v_cvt_pk_bf16_f32 v41, v114, v115
    v_cvt_pk_bf16_f32 v42, v120, v121
    v_cvt_pk_bf16_f32 v43, v122, v123
    v_cvt_pk_bf16_f32 v44, v116, v117
    v_cvt_pk_bf16_f32 v45, v118, v119
    v_cvt_pk_bf16_f32 v46, v124, v125
    v_cvt_pk_bf16_f32 v47, v126, v127
    v_mul_f32 v128, v128, v19
    v_mul_f32 v129, v129, v19
    v_mul_f32 v130, v130, v19
    v_mul_f32 v131, v131, v19
    v_mul_f32 v132, v132, v19
    v_mul_f32 v133, v133, v19
    v_mul_f32 v134, v134, v19
    v_mul_f32 v135, v135, v19
    v_mul_f32 v136, v136, v19
    v_mul_f32 v137, v137, v19
    v_mul_f32 v138, v138, v19
    v_mul_f32 v139, v139, v19
    v_mul_f32 v140, v140, v19
    v_mul_f32 v141, v141, v19
    v_mul_f32 v142, v142, v19
    v_mul_f32 v143, v143, v19
    v_cvt_pk_bf16_f32 v48, v128, v129
    v_cvt_pk_bf16_f32 v49, v130, v131
    v_cvt_pk_bf16_f32 v50, v136, v137
    v_cvt_pk_bf16_f32 v51, v138, v139
    v_cvt_pk_bf16_f32 v52, v132, v133
    v_cvt_pk_bf16_f32 v53, v134, v135
    v_cvt_pk_bf16_f32 v54, v140, v141
    v_cvt_pk_bf16_f32 v55, v142, v143
    v_mul_f32 v144, v144, v19
    v_mul_f32 v145, v145, v19
    v_mul_f32 v146, v146, v19
    v_mul_f32 v147, v147, v19
    v_mul_f32 v148, v148, v19
    v_mul_f32 v149, v149, v19
    v_mul_f32 v150, v150, v19
    v_mul_f32 v151, v151, v19
    v_mul_f32 v152, v152, v19
    v_mul_f32 v153, v153, v19
    v_mul_f32 v154, v154, v19
    v_mul_f32 v155, v155, v19
    v_mul_f32 v156, v156, v19
    v_mul_f32 v157, v157, v19
    v_mul_f32 v158, v158, v19
    v_mul_f32 v159, v159, v19
    v_cvt_pk_bf16_f32 v56, v144, v145
    v_cvt_pk_bf16_f32 v57, v146, v147
    v_cvt_pk_bf16_f32 v58, v152, v153
    v_cvt_pk_bf16_f32 v59, v154, v155
    v_cvt_pk_bf16_f32 v60, v148, v149
    v_cvt_pk_bf16_f32 v61, v150, v151
    v_cvt_pk_bf16_f32 v62, v156, v157
    v_cvt_pk_bf16_f32 v63, v158, v159
    s_waitcnt lgkmcnt(0)
    s_cmp_lg_u32 s65, 0
    s_cbranch_scc1 LF_S_nowait
    s_waitcnt vmcnt(0)
LF_S_nowait:
    s_nop 7
    s_nop 7
    s_setpc_b64 s[58:59]
LF_rare00:
    v_max_f32 v20, s67, v18
    v_max_f32 v21, 0, v20
    v_sub_f32 v21, 0, v21
    v_exp_f32 v21, v21
    v_sub_f32 v160, v160, v20
    v_sub_f32 v161, v161, v20
    v_sub_f32 v162, v162, v20
    v_sub_f32 v163, v163, v20
    v_sub_f32 v164, v164, v20
    v_sub_f32 v165, v165, v20
    v_sub_f32 v166, v166, v20
    v_sub_f32 v167, v167, v20
    v_sub_f32 v168, v168, v20
    v_sub_f32 v169, v169, v20
    v_sub_f32 v170, v170, v20
    v_sub_f32 v171, v171, v20
    v_sub_f32 v172, v172, v20
    v_sub_f32 v173, v173, v20
    v_sub_f32 v174, v174, v20
    v_sub_f32 v175, v175, v20
    v_sub_f32 v176, v176, v20
    v_sub_f32 v177, v177, v20
    v_sub_f32 v178, v178, v20
    v_sub_f32 v179, v179, v20
    v_sub_f32 v180, v180, v20
    v_sub_f32 v181, v181, v20
    v_sub_f32 v182, v182, v20
    v_sub_f32 v183, v183, v20
    v_sub_f32 v184, v184, v20
    v_sub_f32 v185, v185, v20
    v_sub_f32 v186, v186, v20
    v_sub_f32 v187, v187, v20
    v_sub_f32 v188, v188, v20
    v_sub_f32 v189, v189, v20
    v_sub_f32 v190, v190, v20
    v_sub_f32 v191, v191, v20
    v_sub_f32 v192, v192, v20
    v_sub_f32 v193, v193, v20
    v_sub_f32 v194, v194, v20
    v_sub_f32 v195, v195, v20
    v_sub_f32 v196, v196, v20
    v_sub_f32 v197, v197, v20
    v_sub_f32 v198, v198, v20
    v_sub_f32 v199, v199, v20
    v_sub_f32 v200, v200, v20
    v_sub_f32 v201, v201, v20
    v_sub_f32 v202, v202, v20
    v_sub_f32 v203, v203, v20
    v_sub_f32 v204, v204, v20
    v_sub_f32 v205, v205, v20
    v_sub_f32 v206, v206, v20
    v_sub_f32 v207, v207, v20
    v_mul_f32 v17, v17, v21
    v_mul_f32 v16, v16, v21
    v_mul_f32 v96, v96, v21
    v_mul_f32 v97, v97, v21
    v_mul_f32 v98, v98, v21
    v_mul_f32 v99, v99, v21
    v_mul_f32 v100, v100, v21
    v_mul_f32 v101, v101, v21
    v_mul_f32 v102, v102, v21
    v_mul_f32 v103, v103, v21
    v_mul_f32 v104, v104, v21
    v_mul_f32 v105, v105, v21
    v_mul_f32 v106, v106, v21
    v_mul_f32 v107, v107, v21
    v_mul_f32 v108, v108, v21
    v_mul_f32 v109, v109, v21
    v_mul_f32 v110, v110, v21
    v_mul_f32 v111, v111, v21
    v_mul_f32 v112, v112, v21
    v_mul_f32 v113, v113, v21
    v_mul_f32 v114, v114, v21
    v_mul_f32 v115, v115, v21
    v_mul_f32 v116, v116, v21
    v_mul_f32 v117, v117, v21
    v_mul_f32 v118, v118, v21
    v_mul_f32 v119, v119, v21
    v_mul_f32 v120, v120, v21
    v_mul_f32 v121, v121, v21
    v_mul_f32 v122, v122, v21
    v_mul_f32 v123, v123, v21
    v_mul_f32 v124, v124, v21
    v_mul_f32 v125, v125, v21
    v_mul_f32 v126, v126, v21
    v_mul_f32 v127, v127, v21
    v_mul_f32 v128, v128, v21
    v_mul_f32 v129, v129, v21
    v_mul_f32 v130, v130, v21
    v_mul_f32 v131, v131, v21
    v_mul_f32 v132, v132, v21
    v_mul_f32 v133, v133, v21
    v_mul_f32 v134, v134, v21
    v_mul_f32 v135, v135, v21
    v_mul_f32 v136, v136, v21
    v_mul_f32 v137, v137, v21
    v_mul_f32 v138, v138, v21
    v_mul_f32 v139, v139, v21
    v_mul_f32 v140, v140, v21
    v_mul_f32 v141, v141, v21
    v_mul_f32 v142, v142, v21
    v_mul_f32 v143, v143, v21
    v_mul_f32 v144, v144, v21
    v_mul_f32 v145, v145, v21
    v_mul_f32 v146, v146, v21
    v_mul_f32 v147, v147, v21
    v_mul_f32 v148, v148, v21
    v_mul_f32 v149, v149, v21
    v_mul_f32 v150, v150, v21
    v_mul_f32 v151, v151, v21
    v_mul_f32 v152, v152, v21
    v_mul_f32 v153, v153, v21
    v_mul_f32 v154, v154, v21
    v_mul_f32 v155, v155, v21
    v_mul_f32 v156, v156, v21
    v_mul_f32 v157, v157, v21
    v_mul_f32 v158, v158, v21
    v_mul_f32 v159, v159, v21
    s_mov_b32 s34, 0x41000000
    s_mov_b32 s67, 0
    s_branch LF_back00
LF_rare01:
    v_max_f32 v20, s67, v18
    v_max_f32 v21, 0, v20
    v_sub_f32 v21, 0, v21
    v_exp_f32 v21, v21
    v_sub_f32 v160, v160, v20
    v_sub_f32 v161, v161, v20
    v_sub_f32 v162, v162, v20
    v_sub_f32 v163, v163, v20
    v_sub_f32 v164, v164, v20
    v_sub_f32 v165, v165, v20
    v_sub_f32 v166, v166, v20
    v_sub_f32 v167, v167, v20
    v_sub_f32 v168, v168, v20
    v_sub_f32 v169, v169, v20
    v_sub_f32 v170, v170, v20
    v_sub_f32 v171, v171, v20
    v_sub_f32 v172, v172, v20
    v_sub_f32 v173, v173, v20
    v_sub_f32 v174, v174, v20
    v_sub_f32 v175, v175, v20
    v_sub_f32 v176, v176, v20
    v_sub_f32 v177, v177, v20
    v_sub_f32 v178, v178, v20
    v_sub_f32 v179, v179, v20
    v_sub_f32 v180, v180, v20
    v_sub_f32 v181, v181, v20
    v_sub_f32 v182, v182, v20
    v_sub_f32 v183, v183, v20
    v_sub_f32 v184, v184, v20
    v_sub_f32 v185, v185, v20
    v_sub_f32 v186, v186, v20
    v_sub_f32 v187, v187, v20
    v_sub_f32 v188, v188, v20
    v_sub_f32 v189, v189, v20
    v_sub_f32 v190, v190, v20
    v_sub_f32 v191, v191, v20
    v_sub_f32 v192, v192, v20
    v_sub_f32 v193, v193, v20
    v_sub_f32 v194, v194, v20
    v_sub_f32 v195, v195, v20
    v_sub_f32 v196, v196, v20
    v_sub_f32 v197, v197, v20
    v_sub_f32 v198, v198, v20
    v_sub_f32 v199, v199, v20
    v_sub_f32 v200, v200, v20
    v_sub_f32 v201, v201, v20
    v_sub_f32 v202, v202, v20
    v_sub_f32 v203, v203, v20
    v_sub_f32 v204, v204, v20
    v_sub_f32 v205, v205, v20
    v_sub_f32 v206, v206, v20
    v_sub_f32 v207, v207, v20
    v_mul_f32 v17, v17, v21
    v_mul_f32 v16, v16, v21
    v_mul_f32 v96, v96, v21
    v_mul_f32 v97, v97, v21
    v_mul_f32 v98, v98, v21
    v_mul_f32 v99, v99, v21
    v_mul_f32 v100, v100, v21
    v_mul_f32 v101, v101, v21
    v_mul_f32 v102, v102, v21
    v_mul_f32 v103, v103, v21
    v_mul_f32 v104, v104, v21
    v_mul_f32 v105, v105, v21
    v_mul_f32 v106, v106, v21
    v_mul_f32 v107, v107, v21
    v_mul_f32 v108, v108, v21
    v_mul_f32 v109, v109, v21
    v_mul_f32 v110, v110, v21
    v_mul_f32 v111, v111, v21
    v_mul_f32 v112, v112, v21
    v_mul_f32 v113, v113, v21
    v_mul_f32 v114, v114, v21
    v_mul_f32 v115, v115, v21
    v_mul_f32 v116, v116, v21
    v_mul_f32 v117, v117, v21
    v_mul_f32 v118, v118, v21
    v_mul_f32 v119, v119, v21
    v_mul_f32 v120, v120, v21
    v_mul_f32 v121, v121, v21
    v_mul_f32 v122, v122, v21
    v_mul_f32 v123, v123, v21
    v_mul_f32 v124, v124, v21
    v_mul_f32 v125, v125, v21
    v_mul_f32 v126, v126, v21
    v_mul_f32 v127, v127, v21
    v_mul_f32 v128, v128, v21
    v_mul_f32 v129, v129, v21
    v_mul_f32 v130, v130, v21
    v_mul_f32 v131, v131, v21
    v_mul_f32 v132, v132, v21
    v_mul_f32 v133, v133, v21
    v_mul_f32 v134, v134, v21
    v_mul_f32 v135, v135, v21
    v_mul_f32 v136, v136, v21
    v_mul_f32 v137, v137, v21
    v_mul_f32 v138, v138, v21
    v_mul_f32 v139, v139, v21
    v_mul_f32 v140, v140, v21
    v_mul_f32 v141, v141, v21
    v_mul_f32 v142, v142, v21
    v_mul_f32 v143, v143, v21
    v_mul_f32 v144, v144, v21
    v_mul_f32 v145, v145, v21
    v_mul_f32 v146, v146, v21
    v_mul_f32 v147, v147, v21
    v_mul_f32 v148, v148, v21
    v_mul_f32 v149, v149, v21
    v_mul_f32 v150, v150, v21
    v_mul_f32 v151, v151, v21
    v_mul_f32 v152, v152, v21
    v_mul_f32 v153, v153, v21
    v_mul_f32 v154, v154, v21
    v_mul_f32 v155, v155, v21
    v_mul_f32 v156, v156, v21
    v_mul_f32 v157, v157, v21
    v_mul_f32 v158, v158, v21
    v_mul_f32 v159, v159, v21
    s_mov_b32 s34, 0x41000000
    s_mov_b32 s67, 0
    s_branch LF_back01
LF_O:
    v_lshrrev_b32 v20, 3, v1
    v_and_b32 v21, 7, v1
    v_bfe_u32 v22, v1, 4, 2
    v_lshlrev_b32 v22, 1, v22
    v_xor_b32 v21, v21, v22
    v_mul_u32_u24 v20, 1152, v20
    v_lshl_add_u32 v4, v21, 4, v20
    v_add_u32 v5, 8192, v4
    v_add_u32 v6, 16384, v4
    v_add_u32 v7, 24576, v4
    v_lshrrev_b32 v20, 1, v1
    v_and_b32 v21, 1, v1
    v_mul_u32_u24 v20, 1152, v20
    v_lshl_add_u32 v20, v21, 4, v20
    s_mul_i32 s30, s28, 96
    s_sub_u32 s30, 1024, s30
    v_add_u32 v8, s30, v20
    s_lshl_b32 s53, s47, 1
    s_add_u32 s53, s53, s35
    s_mul_i32 s53, s53, 589824
    s_lshl_b32 s30, s28, 7
    s_add_u32 s43, s53, s30
    s_mov_b32 s45, 0
    s_mul_i32 s60, s28, 10240
    s_barrier
    s_cmp_lg_u32 s29, 0
    s_cbranch_scc1 LF_O_p1
    s_add_u32 m0, s60, 0
    s_nop 0
    buffer_load_dwordx4 v4, s[20:23], s43 offen offset:0 lds
    buffer_load_dwordx4 v5, s[20:23], s43 offen offset:1024 lds
    buffer_load_dwordx4 v6, s[20:23], s43 offen offset:2048 lds
    buffer_load_dwordx4 v7, s[20:23], s43 offen offset:3072 lds
    s_add_u32 m0, s60, 4096
    s_nop 0
    buffer_load_dwordx4 v8, s[20:23], s43 offen lds
    s_add_u32 s45, s45, 1
    s_add_u32 s43, s43, 36864
    s_cmp_eq_u32 s45, 32
    s_cselect_b32 s43, 0x7f000000, s43
    s_add_u32 m0, s60, 5120
    s_nop 0
    buffer_load_dwordx4 v4, s[20:23], s43 offen offset:0 lds
    buffer_load_dwordx4 v5, s[20:23], s43 offen offset:1024 lds
    buffer_load_dwordx4 v6, s[20:23], s43 offen offset:2048 lds
    buffer_load_dwordx4 v7, s[20:23], s43 offen offset:3072 lds
    s_add_u32 m0, s60, 9216
    s_nop 0
    buffer_load_dwordx4 v8, s[20:23], s43 offen lds
    s_add_u32 s45, s45, 1
    s_add_u32 s43, s43, 36864
    s_cmp_eq_u32 s45, 32
    s_cselect_b32 s43, 0x7f000000, s43
    s_branch LF_O_p2
LF_O_p1:
    s_add_u32 m0, s60, 0
    s_nop 0
    buffer_load_dwordx4 v4, s[20:23], s43 offen offset:0 lds
    buffer_load_dwordx4 v5, s[20:23], s43 offen offset:1024 lds
    buffer_load_dwordx4 v6, s[20:23], s43 offen offset:2048 lds
    buffer_load_dwordx4 v7, s[20:23], s43 offen offset:3072 lds
    s_add_u32 s45, s45, 1
    s_add_u32 s43, s43, 36864
    s_cmp_eq_u32 s45, 32
    s_cselect_b32 s43, 0x7f000000, s43
    s_add_u32 m0, s60, 5120
    s_nop 0
    buffer_load_dwordx4 v4, s[20:23], s43 offen offset:0 lds
    buffer_load_dwordx4 v5, s[20:23], s43 offen offset:1024 lds
    buffer_load_dwordx4 v6, s[20:23], s43 offen offset:2048 lds
    buffer_load_dwordx4 v7, s[20:23], s43 offen offset:3072 lds
    s_add_u32 s45, s45, 1
    s_add_u32 s43, s43, 36864
    s_cmp_eq_u32 s45, 32
    s_cselect_b32 s43, 0x7f000000, s43
LF_O_p2:
    v_bfe_u32 v20, v1, 4, 1
    v_and_b32 v22, 15, v1
    v_lshrrev_b32 v21, 5, v1
    v_lshlrev_b32 v22, 4, v22
    v_lshl_add_u32 v22, v20, 10, v22
    v_lshl_add_u32 v22, v21, 8, v22
    s_lshr_b32 s30, s28, 1
    s_lshl_b32 s30, s30, 14
    s_and_b32 s31, s28, 1
    s_lshl_b32 s31, s31, 11
    s_add_u32 s30, s30, s31
    s_add_u32 s30, s30, 98304
    v_add_u32 v15, s30, v22
    ds_write_b128 v15, v[64:67] offset:0
    ds_write_b128 v15, v[68:71] offset:512
    ds_write_b128 v15, v[72:75] offset:4096
    ds_write_b128 v15, v[76:79] offset:4608
    ds_write_b128 v15, v[80:83] offset:8192
    ds_write_b128 v15, v[84:87] offset:8704
    ds_write_b128 v15, v[88:91] offset:12288
    ds_write_b128 v15, v[92:95] offset:12800
    v_lshlrev_b32 v20, 4, v1
    v_add_u32 v14, 98304, v20
    v_lshrrev_b32 v20, 2, v1
    v_bfe_u32 v21, v1, 3, 2
    v_and_b32 v22, 3, v1
    v_lshlrev_b32 v23, 7, v20
    v_lshl_add_u32 v23, v22, 3, v23
    v_add_u32 v23, s60, v23
    v_xor_b32 v24, 0, v21
    v_lshl_add_u32 v9, v24, 5, v23
    v_xor_b32 v24, 1, v21
    v_lshl_add_u32 v10, v24, 5, v23
    v_xor_b32 v24, 2, v21
    v_lshl_add_u32 v11, v24, 5, v23
    v_xor_b32 v24, 3, v21
    v_lshl_add_u32 v12, v24, 5, v23
    v_lshlrev_b32 v23, 5, v20
    v_lshl_add_u32 v23, v22, 3, v23
    v_add_u32 v13, s60, v23
    v_mov_b32 v96, 0
    v_mov_b32 v97, 0
    v_mov_b32 v98, 0
    v_mov_b32 v99, 0
    v_mov_b32 v100, 0
    v_mov_b32 v101, 0
    v_mov_b32 v102, 0
    v_mov_b32 v103, 0
    v_mov_b32 v104, 0
    v_mov_b32 v105, 0
    v_mov_b32 v106, 0
    v_mov_b32 v107, 0
    v_mov_b32 v108, 0
    v_mov_b32 v109, 0
    v_mov_b32 v110, 0
    v_mov_b32 v111, 0
    v_mov_b32 v112, 0
    v_mov_b32 v113, 0
    v_mov_b32 v114, 0
    v_mov_b32 v115, 0
    v_mov_b32 v116, 0
    v_mov_b32 v117, 0
    v_mov_b32 v118, 0
    v_mov_b32 v119, 0
    v_mov_b32 v120, 0
    v_mov_b32 v121, 0
    v_mov_b32 v122, 0
    v_mov_b32 v123, 0
    v_mov_b32 v124, 0
    v_mov_b32 v125, 0
    v_mov_b32 v126, 0
    v_mov_b32 v127, 0
    v_mov_b32 v128, 0
    v_mov_b32 v129, 0
    v_mov_b32 v130, 0
    v_mov_b32 v131, 0
    v_mov_b32 v132, 0
    v_mov_b32 v133, 0
    v_mov_b32 v134, 0
    v_mov_b32 v135, 0
    v_mov_b32 v136, 0
    v_mov_b32 v137, 0
    v_mov_b32 v138, 0
    v_mov_b32 v139, 0
    v_mov_b32 v140, 0
    v_mov_b32 v141, 0
    v_mov_b32 v142, 0
    v_mov_b32 v143, 0
    v_mov_b32 v144, 0
    v_mov_b32 v145, 0
    v_mov_b32 v146, 0
    v_mov_b32 v147, 0
    v_mov_b32 v148, 0
    v_mov_b32 v149, 0
    v_mov_b32 v150, 0
    v_mov_b32 v151, 0
    v_mov_b32 v152, 0
    v_mov_b32 v153, 0
    v_mov_b32 v154, 0
    v_mov_b32 v155, 0
    v_mov_b32 v156, 0
    v_mov_b32 v157, 0
    v_mov_b32 v158, 0
    v_mov_b32 v159, 0
    v_mov_b32 v160, 0
    v_mov_b32 v161, 0
    v_mov_b32 v162, 0
    v_mov_b32 v163, 0
    v_mov_b32 v164, 0
    v_mov_b32 v165, 0
    v_mov_b32 v166, 0
    v_mov_b32 v167, 0
    v_mov_b32 v168, 0
    v_mov_b32 v169, 0
    v_mov_b32 v170, 0
    v_mov_b32 v171, 0
    v_mov_b32 v172, 0
    v_mov_b32 v173, 0
    v_mov_b32 v174, 0
    v_mov_b32 v175, 0
    s_waitcnt lgkmcnt(0)
    s_barrier
    s_cmp_lg_u32 s29, 0
    s_cbranch_scc1 LF_O_b1
    s_waitcnt vmcnt(5)
    ds_read_b64_tr_b16 v[176:177], v9 offset:0
    ds_read_b64_tr_b16 v[178:179], v9 offset:2048
    ds_read_b64_tr_b16 v[180:181], v10 offset:0
    ds_read_b64_tr_b16 v[182:183], v10 offset:2048
    ds_read_b64_tr_b16 v[184:185], v11 offset:0
    ds_read_b64_tr_b16 v[186:187], v11 offset:2048
    ds_read_b64_tr_b16 v[188:189], v12 offset:0
    ds_read_b64_tr_b16 v[190:191], v12 offset:2048
    ds_read_b64_tr_b16 v[192:193], v13 offset:4096
    ds_read_b64_tr_b16 v[194:195], v13 offset:4608
    ds_read_b128 v[216:219], v14 offset:0
    ds_read_b128 v[220:223], v14 offset:1024
    ds_read_b128 v[224:227], v14 offset:2048
    ds_read_b128 v[228:231], v14 offset:3072
    s_waitcnt lgkmcnt(0)
    s_add_u32 m0, s60, 0
    s_nop 0
    buffer_load_dwordx4 v4, s[20:23], s43 offen offset:0 lds
    buffer_load_dwordx4 v5, s[20:23], s43 offen offset:1024 lds
    buffer_load_dwordx4 v6, s[20:23], s43 offen offset:2048 lds
    buffer_load_dwordx4 v7, s[20:23], s43 offen offset:3072 lds
    s_add_u32 m0, s60, 4096
    s_nop 0
    buffer_load_dwordx4 v8, s[20:23], s43 offen lds
    s_add_u32 s45, s45, 1
    s_add_u32 s43, s43, 36864
    s_cmp_eq_u32 s45, 32
    s_cselect_b32 s43, 0x7f000000, s43
    s_mov_b32 s36, 0
LF_Oloop0:
    s_waitcnt vmcnt(5)
    v_mfma_f32_16x16x32_bf16 v[96:99], v[176:179], v[216:219], v[96:99]
    ds_read_b64_tr_b16 v[196:197], v9 offset:5120
    ds_read_b64_tr_b16 v[198:199], v9 offset:7168
    v_mfma_f32_16x16x32_bf16 v[100:103], v[176:179], v[220:223], v[100:103]
    ds_read_b64_tr_b16 v[200:201], v10 offset:5120
    ds_read_b64_tr_b16 v[202:203], v10 offset:7168
    v_mfma_f32_16x16x32_bf16 v[104:107], v[176:179], v[224:227], v[104:107]
    ds_read_b64_tr_b16 v[204:205], v11 offset:5120
    ds_read_b64_tr_b16 v[206:207], v11 offset:7168
    v_mfma_f32_16x16x32_bf16 v[108:111], v[176:179], v[228:231], v[108:111]
    ds_read_b64_tr_b16 v[208:209], v12 offset:5120
    ds_read_b64_tr_b16 v[210:211], v12 offset:7168
    v_mfma_f32_16x16x32_bf16 v[112:115], v[180:183], v[216:219], v[112:115]
    ds_read_b64_tr_b16 v[212:213], v13 offset:9216
    ds_read_b64_tr_b16 v[214:215], v13 offset:9728
    v_mfma_f32_16x16x32_bf16 v[116:119], v[180:183], v[220:223], v[116:119]
    ds_read_b128 v[232:235], v14 offset:4096
    v_mfma_f32_16x16x32_bf16 v[120:123], v[180:183], v[224:227], v[120:123]
    ds_read_b128 v[236:239], v14 offset:5120
    v_mfma_f32_16x16x32_bf16 v[124:127], v[180:183], v[228:231], v[124:127]
    ds_read_b128 v[240:243], v14 offset:6144
    v_mfma_f32_16x16x32_bf16 v[128:131], v[184:187], v[216:219], v[128:131]
    ds_read_b128 v[244:247], v14 offset:7168
    v_mfma_f32_16x16x32_bf16 v[132:135], v[184:187], v[220:223], v[132:135]
    v_mfma_f32_16x16x32_bf16 v[136:139], v[184:187], v[224:227], v[136:139]
    s_waitcnt lgkmcnt(4)
    s_add_u32 m0, s60, 5120
    s_nop 0
    buffer_load_dwordx4 v4, s[20:23], s43 offen offset:0 lds
    v_mfma_f32_16x16x32_bf16 v[140:143], v[184:187], v[228:231], v[140:143]
    v_mfma_f32_16x16x32_bf16 v[144:147], v[188:191], v[216:219], v[144:147]
    buffer_load_dwordx4 v5, s[20:23], s43 offen offset:1024 lds
    v_mfma_f32_16x16x32_bf16 v[148:151], v[188:191], v[220:223], v[148:151]
    v_mfma_f32_16x16x32_bf16 v[152:155], v[188:191], v[224:227], v[152:155]
    buffer_load_dwordx4 v6, s[20:23], s43 offen offset:2048 lds
    v_mfma_f32_16x16x32_bf16 v[156:159], v[188:191], v[228:231], v[156:159]
    v_mfma_f32_16x16x32_bf16 v[160:163], v[192:195], v[216:219], v[160:163]
    buffer_load_dwordx4 v7, s[20:23], s43 offen offset:3072 lds
    s_add_u32 m0, s60, 9216
    s_nop 0
    buffer_load_dwordx4 v8, s[20:23], s43 offen lds
    s_add_u32 s45, s45, 1
    s_add_u32 s43, s43, 36864
    s_cmp_eq_u32 s45, 32
    s_cselect_b32 s43, 0x7f000000, s43
    v_mfma_f32_16x16x32_bf16 v[164:167], v[192:195], v[220:223], v[164:167]
    v_mfma_f32_16x16x32_bf16 v[168:171], v[192:195], v[224:227], v[168:171]
    v_mfma_f32_16x16x32_bf16 v[172:175], v[192:195], v[228:231], v[172:175]
    s_waitcnt lgkmcnt(0)
    s_waitcnt vmcnt(5)
    v_mfma_f32_16x16x32_bf16 v[96:99], v[196:199], v[232:235], v[96:99]
    ds_read_b64_tr_b16 v[176:177], v9 offset:0
    ds_read_b64_tr_b16 v[178:179], v9 offset:2048
    v_mfma_f32_16x16x32_bf16 v[100:103], v[196:199], v[236:239], v[100:103]
    ds_read_b64_tr_b16 v[180:181], v10 offset:0
    ds_read_b64_tr_b16 v[182:183], v10 offset:2048
    v_mfma_f32_16x16x32_bf16 v[104:107], v[196:199], v[240:243], v[104:107]
    ds_read_b64_tr_b16 v[184:185], v11 offset:0
    ds_read_b64_tr_b16 v[186:187], v11 offset:2048
    v_mfma_f32_16x16x32_bf16 v[108:111], v[196:199], v[244:247], v[108:111]
    ds_read_b64_tr_b16 v[188:189], v12 offset:0
    ds_read_b64_tr_b16 v[190:191], v12 offset:2048
    v_mfma_f32_16x16x32_bf16 v[112:115], v[200:203], v[232:235], v[112:115]
    ds_read_b64_tr_b16 v[192:193], v13 offset:4096
    ds_read_b64_tr_b16 v[194:195], v13 offset:4608
    v_mfma_f32_16x16x32_bf16 v[116:119], v[200:203], v[236:239], v[116:119]
    ds_read_b128 v[216:219], v14 offset:8192
    v_mfma_f32_16x16x32_bf16 v[120:123], v[200:203], v[240:243], v[120:123]
    ds_read_b128 v[220:223], v14 offset:9216
    v_mfma_f32_16x16x32_bf16 v[124:127], v[200:203], v[244:247], v[124:127]
    ds_read_b128 v[224:227], v14 offset:10240
    v_mfma_f32_16x16x32_bf16 v[128:131], v[204:207], v[232:235], v[128:131]
    ds_read_b128 v[228:231], v14 offset:11264
    v_mfma_f32_16x16x32_bf16 v[132:135], v[204:207], v[236:239], v[132:135]
    v_mfma_f32_16x16x32_bf16 v[136:139], v[204:207], v[240:243], v[136:139]
    s_waitcnt lgkmcnt(4)
    s_add_u32 m0, s60, 0
    s_nop 0
    buffer_load_dwordx4 v4, s[20:23], s43 offen offset:0 lds
    v_mfma_f32_16x16x32_bf16 v[140:143], v[204:207], v[244:247], v[140:143]
    v_mfma_f32_16x16x32_bf16 v[144:147], v[208:211], v[232:235], v[144:147]
    buffer_load_dwordx4 v5, s[20:23], s43 offen offset:1024 lds
    v_mfma_f32_16x16x32_bf16 v[148:151], v[208:211], v[236:239], v[148:151]
    v_mfma_f32_16x16x32_bf16 v[152:155], v[208:211], v[240:243], v[152:155]
    buffer_load_dwordx4 v6, s[20:23], s43 offen offset:2048 lds
    v_mfma_f32_16x16x32_bf16 v[156:159], v[208:211], v[244:247], v[156:159]
    v_mfma_f32_16x16x32_bf16 v[160:163], v[212:215], v[232:235], v[160:163]
    buffer_load_dwordx4 v7, s[20:23], s43 offen offset:3072 lds
    s_add_u32 m0, s60, 4096
    s_nop 0
    buffer_load_dwordx4 v8, s[20:23], s43 offen lds
    s_add_u32 s45, s45, 1
    s_add_u32 s43, s43, 36864
    s_cmp_eq_u32 s45, 32
    s_cselect_b32 s43, 0x7f000000, s43
    v_mfma_f32_16x16x32_bf16 v[164:167], v[212:215], v[236:239], v[164:167]
    v_mfma_f32_16x16x32_bf16 v[168:171], v[212:215], v[240:243], v[168:171]
    v_mfma_f32_16x16x32_bf16 v[172:175], v[212:215], v[244:247], v[172:175]
    s_waitcnt lgkmcnt(0)
    v_add_u32 v14, 8192, v14
    s_add_u32 s36, s36, 1
    s_cmp_lg_u32 s36, 8
    s_cbranch_scc1 LF_O_nomid0
    s_barrier
    ds_write_b128 v15, v[32:35] offset:0
    ds_write_b128 v15, v[36:39] offset:512
    ds_write_b128 v15, v[40:43] offset:4096
    ds_write_b128 v15, v[44:47] offset:4608
    ds_write_b128 v15, v[48:51] offset:8192
    ds_write_b128 v15, v[52:55] offset:8704
    ds_write_b128 v15, v[56:59] offset:12288
    ds_write_b128 v15, v[60:63] offset:12800
    v_subrev_u32 v14, 65536, v14
    s_waitcnt lgkmcnt(0)
    s_barrier
    ds_read_b128 v[216:219], v14 offset:0
    ds_read_b128 v[220:223], v14 offset:1024
    ds_read_b128 v[224:227], v14 offset:2048
    ds_read_b128 v[228:231], v14 offset:3072
    s_waitcnt lgkmcnt(0)
LF_O_nomid0:
    s_cmp_lt_u32 s36, 16
    s_cbranch_scc1 LF_Oloop0
    s_waitcnt vmcnt(0)
    v_lshlrev_b32 v20, 4, v1
    s_lshl_b32 s30, s28, 13
    s_add_u32 s30, s30, s54
    v_cvt_pk_bf16_f32 v176, v96, v97
    v_cvt_pk_bf16_f32 v177, v98, v99
    v_cvt_pk_bf16_f32 v178, v100, v101
    v_cvt_pk_bf16_f32 v179, v102, v103
    buffer_store_dwordx4 v[176:179], v20, s[24:27], s30 offen offset:0
    v_cvt_pk_bf16_f32 v180, v104, v105
    v_cvt_pk_bf16_f32 v181, v106, v107
    v_cvt_pk_bf16_f32 v182, v108, v109
    v_cvt_pk_bf16_f32 v183, v110, v111
    buffer_store_dwordx4 v[180:183], v20, s[24:27], s30 offen offset:1024
    v_cvt_pk_bf16_f32 v184, v112, v113
    v_cvt_pk_bf16_f32 v185, v114, v115
    v_cvt_pk_bf16_f32 v186, v116, v117
    v_cvt_pk_bf16_f32 v187, v118, v119
    buffer_store_dwordx4 v[184:187], v20, s[24:27], s30 offen offset:2048
    v_cvt_pk_bf16_f32 v188, v120, v121
    v_cvt_pk_bf16_f32 v189, v122, v123
    v_cvt_pk_bf16_f32 v190, v124, v125
    v_cvt_pk_bf16_f32 v191, v126, v127
    buffer_store_dwordx4 v[188:191], v20, s[24:27], s30 offen offset:3072
    v_cvt_pk_bf16_f32 v192, v128, v129
    v_cvt_pk_bf16_f32 v193, v130, v131
    v_cvt_pk_bf16_f32 v194, v132, v133
    v_cvt_pk_bf16_f32 v195, v134, v135
    s_add_u32 s30, s30, 4096
    buffer_store_dwordx4 v[192:195], v20, s[24:27], s30 offen offset:0
    v_cvt_pk_bf16_f32 v196, v136, v137
    v_cvt_pk_bf16_f32 v197, v138, v139
    v_cvt_pk_bf16_f32 v198, v140, v141
    v_cvt_pk_bf16_f32 v199, v142, v143
    buffer_store_dwordx4 v[196:199], v20, s[24:27], s30 offen offset:1024
    v_cvt_pk_bf16_f32 v200, v144, v145
    v_cvt_pk_bf16_f32 v201, v146, v147
    v_cvt_pk_bf16_f32 v202, v148, v149
    v_cvt_pk_bf16_f32 v203, v150, v151
    buffer_store_dwordx4 v[200:203], v20, s[24:27], s30 offen offset:2048
    v_cvt_pk_bf16_f32 v204, v152, v153
    v_cvt_pk_bf16_f32 v205, v154, v155
    v_cvt_pk_bf16_f32 v206, v156, v157
    v_cvt_pk_bf16_f32 v207, v158, v159
    buffer_store_dwordx4 v[204:207], v20, s[24:27], s30 offen offset:3072
    v_cvt_pk_bf16_f32 v208, v160, v161
    v_cvt_pk_bf16_f32 v209, v162, v163
    v_cvt_pk_bf16_f32 v210, v164, v165
    v_cvt_pk_bf16_f32 v211, v166, v167
    s_lshl_b32 s30, s28, 11
    s_add_u32 s30, s30, s54
    s_add_u32 s30, s30, 65536
    buffer_store_dwordx4 v[208:211], v20, s[24:27], s30 offen offset:0
    v_cvt_pk_bf16_f32 v212, v168, v169
    v_cvt_pk_bf16_f32 v213, v170, v171
    v_cvt_pk_bf16_f32 v214, v172, v173
    v_cvt_pk_bf16_f32 v215, v174, v175
    buffer_store_dwordx4 v[212:215], v20, s[24:27], s30 offen offset:1024
    s_branch LF_O_ns
LF_O_b1:
    s_waitcnt vmcnt(4)
    ds_read_b64_tr_b16 v[176:177], v9 offset:0
    ds_read_b64_tr_b16 v[178:179], v9 offset:2048
    ds_read_b64_tr_b16 v[180:181], v10 offset:0
    ds_read_b64_tr_b16 v[182:183], v10 offset:2048
    ds_read_b64_tr_b16 v[184:185], v11 offset:0
    ds_read_b64_tr_b16 v[186:187], v11 offset:2048
    ds_read_b64_tr_b16 v[188:189], v12 offset:0
    ds_read_b64_tr_b16 v[190:191], v12 offset:2048
    ds_read_b128 v[216:219], v14 offset:0
    ds_read_b128 v[220:223], v14 offset:1024
    ds_read_b128 v[224:227], v14 offset:2048
    ds_read_b128 v[228:231], v14 offset:3072
    s_waitcnt lgkmcnt(0)
    s_add_u32 m0, s60, 0
    s_nop 0
    buffer_load_dwordx4 v4, s[20:23], s43 offen offset:0 lds
    buffer_load_dwordx4 v5, s[20:23], s43 offen offset:1024 lds
    buffer_load_dwordx4 v6, s[20:23], s43 offen offset:2048 lds
    buffer_load_dwordx4 v7, s[20:23], s43 offen offset:3072 lds
    s_add_u32 s45, s45, 1
    s_add_u32 s43, s43, 36864
    s_cmp_eq_u32 s45, 32
    s_cselect_b32 s43, 0x7f000000, s43
    s_mov_b32 s36, 0
LF_Oloop1:
    s_waitcnt vmcnt(4)
    v_mfma_f32_16x16x32_bf16 v[96:99], v[176:179], v[216:219], v[96:99]
    ds_read_b64_tr_b16 v[196:197], v9 offset:5120
    ds_read_b64_tr_b16 v[198:199], v9 offset:7168
    v_mfma_f32_16x16x32_bf16 v[100:103], v[176:179], v[220:223], v[100:103]
    ds_read_b64_tr_b16 v[200:201], v10 offset:5120
    ds_read_b64_tr_b16 v[202:203], v10 offset:7168
    v_mfma_f32_16x16x32_bf16 v[104:107], v[176:179], v[224:227], v[104:107]
    ds_read_b64_tr_b16 v[204:205], v11 offset:5120
    ds_read_b64_tr_b16 v[206:207], v11 offset:7168
    v_mfma_f32_16x16x32_bf16 v[108:111], v[176:179], v[228:231], v[108:111]
    ds_read_b64_tr_b16 v[208:209], v12 offset:5120
    ds_read_b64_tr_b16 v[210:211], v12 offset:7168
    v_mfma_f32_16x16x32_bf16 v[112:115], v[180:183], v[216:219], v[112:115]
    ds_read_b128 v[232:235], v14 offset:4096
    v_mfma_f32_16x16x32_bf16 v[116:119], v[180:183], v[220:223], v[116:119]
    ds_read_b128 v[236:239], v14 offset:5120
    v_mfma_f32_16x16x32_bf16 v[120:123], v[180:183], v[224:227], v[120:123]
    ds_read_b128 v[240:243], v14 offset:6144
    v_mfma_f32_16x16x32_bf16 v[124:127], v[180:183], v[228:231], v[124:127]
    ds_read_b128 v[244:247], v14 offset:7168
    v_mfma_f32_16x16x32_bf16 v[128:131], v[184:187], v[216:219], v[128:131]
    v_mfma_f32_16x16x32_bf16 v[132:135], v[184:187], v[220:223], v[132:135]
    s_waitcnt lgkmcnt(4)
    s_add_u32 m0, s60, 5120
    s_nop 0
    buffer_load_dwordx4 v4, s[20:23], s43 offen offset:0 lds
    v_mfma_f32_16x16x32_bf16 v[136:139], v[184:187], v[224:227], v[136:139]
    v_mfma_f32_16x16x32_bf16 v[140:143], v[184:187], v[228:231], v[140:143]
    buffer_load_dwordx4 v5, s[20:23], s43 offen offset:1024 lds
    v_mfma_f32_16x16x32_bf16 v[144:147], v[188:191], v[216:219], v[144:147]
    v_mfma_f32_16x16x32_bf16 v[148:151], v[188:191], v[220:223], v[148:151]
    buffer_load_dwordx4 v6, s[20:23], s43 offen offset:2048 lds
    v_mfma_f32_16x16x32_bf16 v[152:155], v[188:191], v[224:227], v[152:155]
    v_mfma_f32_16x16x32_bf16 v[156:159], v[188:191], v[228:231], v[156:159]
    buffer_load_dwordx4 v7, s[20:23], s43 offen offset:3072 lds
    s_add_u32 s45, s45, 1
    s_add_u32 s43, s43, 36864
    s_cmp_eq_u32 s45, 32
    s_cselect_b32 s43, 0x7f000000, s43
    s_waitcnt lgkmcnt(0)
    s_waitcnt vmcnt(4)
    v_mfma_f32_16x16x32_bf16 v[96:99], v[196:199], v[232:235], v[96:99]
    ds_read_b64_tr_b16 v[176:177], v9 offset:0
    ds_read_b64_tr_b16 v[178:179], v9 offset:2048
    v_mfma_f32_16x16x32_bf16 v[100:103], v[196:199], v[236:239], v[100:103]
    ds_read_b64_tr_b16 v[180:181], v10 offset:0
    ds_read_b64_tr_b16 v[182:183], v10 offset:2048
    v_mfma_f32_16x16x32_bf16 v[104:107], v[196:199], v[240:243], v[104:107]
    ds_read_b64_tr_b16 v[184:185], v11 offset:0
    ds_read_b64_tr_b16 v[186:187], v11 offset:2048
    v_mfma_f32_16x16x32_bf16 v[108:111], v[196:199], v[244:247], v[108:111]
    ds_read_b64_tr_b16 v[188:189], v12 offset:0
    ds_read_b64_tr_b16 v[190:191], v12 offset:2048
    v_mfma_f32_16x16x32_bf16 v[112:115], v[200:203], v[232:235], v[112:115]
    ds_read_b128 v[216:219], v14 offset:8192
    v_mfma_f32_16x16x32_bf16 v[116:119], v[200:203], v[236:239], v[116:119]
    ds_read_b128 v[220:223], v14 offset:9216
    v_mfma_f32_16x16x32_bf16 v[120:123], v[200:203], v[240:243], v[120:123]
    ds_read_b128 v[224:227], v14 offset:10240
    v_mfma_f32_16x16x32_bf16 v[124:127], v[200:203], v[244:247], v[124:127]
    ds_read_b128 v[228:231], v14 offset:11264
    v_mfma_f32_16x16x32_bf16 v[128:131], v[204:207], v[232:235], v[128:131]
    v_mfma_f32_16x16x32_bf16 v[132:135], v[204:207], v[236:239], v[132:135]
    s_waitcnt lgkmcnt(4)
    s_add_u32 m0, s60, 0
    s_nop 0
    buffer_load_dwordx4 v4, s[20:23], s43 offen offset:0 lds
    v_mfma_f32_16x16x32_bf16 v[136:139], v[204:207], v[240:243], v[136:139]
    v_mfma_f32_16x16x32_bf16 v[140:143], v[204:207], v[244:247], v[140:143]
    buffer_load_dwordx4 v5, s[20:23], s43 offen offset:1024 lds
    v_mfma_f32_16x16x32_bf16 v[144:147], v[208:211], v[232:235], v[144:147]
    v_mfma_f32_16x16x32_bf16 v[148:151], v[208:211], v[236:239], v[148:151]
    buffer_load_dwordx4 v6, s[20:23], s43 offen offset:2048 lds
    v_mfma_f32_16x16x32_bf16 v[152:155], v[208:211], v[240:243], v[152:155]
    v_mfma_f32_16x16x32_bf16 v[156:159], v[208:211], v[244:247], v[156:159]
    buffer_load_dwordx4 v7, s[20:23], s43 offen offset:3072 lds
    s_add_u32 s45, s45, 1
    s_add_u32 s43, s43, 36864
    s_cmp_eq_u32 s45, 32
    s_cselect_b32 s43, 0x7f000000, s43
    s_waitcnt lgkmcnt(0)
    v_add_u32 v14, 8192, v14
    s_add_u32 s36, s36, 1
    s_cmp_lg_u32 s36, 8
    s_cbranch_scc1 LF_O_nomid1
    s_barrier
    ds_write_b128 v15, v[32:35] offset:0
    ds_write_b128 v15, v[36:39] offset:512
    ds_write_b128 v15, v[40:43] offset:4096
    ds_write_b128 v15, v[44:47] offset:4608
    ds_write_b128 v15, v[48:51] offset:8192
    ds_write_b128 v15, v[52:55] offset:8704
    ds_write_b128 v15, v[56:59] offset:12288
    ds_write_b128 v15, v[60:63] offset:12800
    v_subrev_u32 v14, 65536, v14
    s_waitcnt lgkmcnt(0)
    s_barrier
    ds_read_b128 v[216:219], v14 offset:0
    ds_read_b128 v[220:223], v14 offset:1024
    ds_read_b128 v[224:227], v14 offset:2048
    ds_read_b128 v[228:231], v14 offset:3072
    s_waitcnt lgkmcnt(0)
LF_O_nomid1:
    s_cmp_lt_u32 s36, 16
    s_cbranch_scc1 LF_Oloop1
    s_waitcnt vmcnt(0)
    v_lshlrev_b32 v20, 4, v1
    s_lshl_b32 s30, s28, 13
    s_add_u32 s30, s30, s54
    v_cvt_pk_bf16_f32 v176, v96, v97
    v_cvt_pk_bf16_f32 v177, v98, v99
    v_cvt_pk_bf16_f32 v178, v100, v101
    v_cvt_pk_bf16_f32 v179, v102, v103
    buffer_store_dwordx4 v[176:179], v20, s[24:27], s30 offen offset:0
    v_cvt_pk_bf16_f32 v180, v104, v105
    v_cvt_pk_bf16_f32 v181, v106, v107
    v_cvt_pk_bf16_f32 v182, v108, v109
    v_cvt_pk_bf16_f32 v183, v110, v111
    buffer_store_dwordx4 v[180:183], v20, s[24:27], s30 offen offset:1024
    v_cvt_pk_bf16_f32 v184, v112, v113
    v_cvt_pk_bf16_f32 v185, v114, v115
    v_cvt_pk_bf16_f32 v186, v116, v117
    v_cvt_pk_bf16_f32 v187, v118, v119
    buffer_store_dwordx4 v[184:187], v20, s[24:27], s30 offen offset:2048
    v_cvt_pk_bf16_f32 v188, v120, v121
    v_cvt_pk_bf16_f32 v189, v122, v123
    v_cvt_pk_bf16_f32 v190, v124, v125
    v_cvt_pk_bf16_f32 v191, v126, v127
    buffer_store_dwordx4 v[188:191], v20, s[24:27], s30 offen offset:3072
    v_cvt_pk_bf16_f32 v192, v128, v129
    v_cvt_pk_bf16_f32 v193, v130, v131
    v_cvt_pk_bf16_f32 v194, v132, v133
    v_cvt_pk_bf16_f32 v195, v134, v135
    s_add_u32 s30, s30, 4096
    buffer_store_dwordx4 v[192:195], v20, s[24:27], s30 offen offset:0
    v_cvt_pk_bf16_f32 v196, v136, v137
    v_cvt_pk_bf16_f32 v197, v138, v139
    v_cvt_pk_bf16_f32 v198, v140, v141
    v_cvt_pk_bf16_f32 v199, v142, v143
    buffer_store_dwordx4 v[196:199], v20, s[24:27], s30 offen offset:1024
    v_cvt_pk_bf16_f32 v200, v144, v145
    v_cvt_pk_bf16_f32 v201, v146, v147
    v_cvt_pk_bf16_f32 v202, v148, v149
    v_cvt_pk_bf16_f32 v203, v150, v151
    buffer_store_dwordx4 v[200:203], v20, s[24:27], s30 offen offset:2048
    v_cvt_pk_bf16_f32 v204, v152, v153
    v_cvt_pk_bf16_f32 v205, v154, v155
    v_cvt_pk_bf16_f32 v206, v156, v157
    v_cvt_pk_bf16_f32 v207, v158, v159
    buffer_store_dwordx4 v[204:207], v20, s[24:27], s30 offen offset:3072
LF_O_ns:
    s_nop 7
    s_nop 7
    s_setpc_b64 s[58:59]
.globl reduce_kernel
.p2align 8
.type reduce_kernel,@function
reduce_kernel:
    s_cmp_ge_u32 s2, 1152
    s_cbranch_scc1 LR_done
    s_load_dwordx2 s[16:17], s[0:1], 80
    s_load_dwordx2 s[18:19], s[0:1], 96
    s_mul_i32 s20, s2, 3641
    s_lshr_b32 s20, s20, 16
    s_mul_i32 s21, s20, 18
    s_sub_u32 s21, s2, s21
    v_lshrrev_b32 v1, 6, v0
    s_nop 0
    v_readfirstlane_b32 s22, v1
    s_lshl_b32 s23, s21, 2
    s_add_u32 s23, s23, s22
    s_lshr_b32 s24, s23, 1
    s_and_b32 s25, s23, 1
    v_and_b32 v1, 63, v0
    v_lshlrev_b32 v2, 4, v1
    s_waitcnt lgkmcnt(0)
    s_mov_b32 s4, s16
    s_and_b32 s5, s17, 0xffff
    s_mov_b32 s6, 0x480000
    s_mov_b32 s7, 0x00020000
    s_mov_b32 s8, s18
    s_and_b32 s9, s19, 0xffff
    s_mov_b32 s10, 0x2400000
    s_mov_b32 s11, 0x00020000
    s_mul_i32 s26, s20, 589824
    s_lshl_b32 s27, s23, 10
    s_add_u32 s26, s26, s27
    s_and_b32 s28, s20, 1
    s_add_u32 s30, s26, 0
    buffer_load_dwordx4 v[8:11], v2, s[8:11], s30 offen
    s_add_u32 s30, s26, 147456
    buffer_load_dwordx4 v[12:15], v2, s[8:11], s30 offen
    s_add_u32 s30, s26, 294912
    buffer_load_dwordx4 v[16:19], v2, s[8:11], s30 offen
    s_add_u32 s30, s26, 442368
    buffer_load_dwordx4 v[20:23], v2, s[8:11], s30 offen
    s_and_b32 s31, s20, 31
    s_lshr_b32 s32, s20, 5
    s_lshl_b32 s31, s31, 6
    s_lshl_b32 s33, s25, 5
    s_add_u32 s31, s31, s33
    s_mul_i32 s31, s31, 2304
    s_mul_i32 s32, s32, 1152
    s_add_u32 s31, s31, s32
    s_lshl_b32 s33, s24, 5
    s_add_u32 s31, s31, s33
    v_and_b32 v3, 15, v1
    v_mul_u32_u24 v3, 2304, v3
    v_lshrrev_b32 v4, 4, v1
    v_lshl_add_u32 v3, v4, 3, v3
    s_waitcnt vmcnt(3)
    v_lshlrev_b32 v32, 16, v8
    v_and_b32 v33, 0xffff0000, v8
    v_lshlrev_b32 v34, 16, v9
    v_and_b32 v35, 0xffff0000, v9
    v_lshlrev_b32 v36, 16, v10
    v_and_b32 v37, 0xffff0000, v10
    v_lshlrev_b32 v38, 16, v11
    v_and_b32 v39, 0xffff0000, v11
    s_waitcnt vmcnt(2)
    v_lshlrev_b32 v40, 16, v12
    v_and_b32 v41, 0xffff0000, v12
    v_add_f32 v32, v32, v40
    v_add_f32 v33, v33, v41
    v_lshlrev_b32 v40, 16, v13
    v_and_b32 v41, 0xffff0000, v13
    v_add_f32 v34, v34, v40
    v_add_f32 v35, v35, v41
    v_lshlrev_b32 v40, 16, v14
    v_and_b32 v41, 0xffff0000, v14
    v_add_f32 v36, v36, v40
    v_add_f32 v37, v37, v41
    v_lshlrev_b32 v40, 16, v15
    v_and_b32 v41, 0xffff0000, v15
    v_add_f32 v38, v38, v40
    v_add_f32 v39, v39, v41
    s_waitcnt vmcnt(1)
    v_lshlrev_b32 v40, 16, v16
    v_and_b32 v41, 0xffff0000, v16
    v_add_f32 v32, v32, v40
    v_add_f32 v33, v33, v41
    v_lshlrev_b32 v40, 16, v17
    v_and_b32 v41, 0xffff0000, v17
    v_add_f32 v34, v34, v40
    v_add_f32 v35, v35, v41
    v_lshlrev_b32 v40, 16, v18
    v_and_b32 v41, 0xffff0000, v18
    v_add_f32 v36, v36, v40
    v_add_f32 v37, v37, v41
    v_lshlrev_b32 v40, 16, v19
    v_and_b32 v41, 0xffff0000, v19
    v_add_f32 v38, v38, v40
    v_add_f32 v39, v39, v41
    s_waitcnt vmcnt(0)
    v_lshlrev_b32 v40, 16, v20
    v_and_b32 v41, 0xffff0000, v20
    v_add_f32 v32, v32, v40
    v_add_f32 v33, v33, v41
    v_lshlrev_b32 v40, 16, v21
    v_and_b32 v41, 0xffff0000, v21
    v_add_f32 v34, v34, v40
    v_add_f32 v35, v35, v41
    v_lshlrev_b32 v40, 16, v22
    v_and_b32 v41, 0xffff0000, v22
    v_add_f32 v36, v36, v40
    v_add_f32 v37, v37, v41
    v_lshlrev_b32 v40, 16, v23
    v_and_b32 v41, 0xffff0000, v23
    v_add_f32 v38, v38, v40
    v_add_f32 v39, v39, v41
    v_cvt_pk_bf16_f32 v44, v32, v33
    v_cvt_pk_bf16_f32 v45, v34, v35
    v_cvt_pk_bf16_f32 v46, v36, v37
    v_cvt_pk_bf16_f32 v47, v38, v39
    buffer_store_dwordx2 v[44:45], v3, s[4:7], s31 offen
    s_add_u32 s31, s31, 36864
    buffer_store_dwordx2 v[46:47], v3, s[4:7], s31 offen
LR_done:
    s_endpgm
LCODE_END:
.section .rodata,"a"
.p2align 6
.amdhsa_kernel fused_kernel
  .amdhsa_next_free_vgpr 256
  .amdhsa_next_free_sgpr 102
  .amdhsa_accum_offset 256
  .amdhsa_group_segment_fixed_size 0
  .amdhsa_kernarg_size 104
  .amdhsa_user_sgpr_count 2
  .amdhsa_user_sgpr_kernarg_segment_ptr 1
  .amdhsa_system_sgpr_workgroup_id_x 1
.end_amdhsa_kernel
.p2align 6
.amdhsa_kernel reduce_kernel
  .amdhsa_next_free_vgpr 48
  .amdhsa_next_free_sgpr 40
  .amdhsa_accum_offset 48
  .amdhsa_group_segment_fixed_size 0
  .amdhsa_kernarg_size 104
  .amdhsa_user_sgpr_count 2
  .amdhsa_user_sgpr_kernarg_segment_ptr 1
  .amdhsa_system_sgpr_workgroup_id_x 1
.end_amdhsa_kernel
```
